```python
import torch

def _softmax(x, axis=-1):
    return torch.softmax(x, dim=axis)

def _gelu(x):
    return torch.nn.functional.gelu(x, approximate='tanh')

def _silu(x):
    return torch.nn.functional.silu(x)

def _sigmoid(x):
    return torch.sigmoid(x)

def _layernorm(x, axis=-1, eps=1e-05):
    m = x.mean(dim=axis, keepdim=True)
    v = x.var(dim=axis, keepdim=True, unbiased=False)
    return (x - m) / torch.sqrt(v + eps)

def _scatter_add(tgt, idx, src, axis=0):
    return tgt.clone().index_add_(axis, idx, src)

def _segment_sum(src, seg, n):
    out = torch.zeros((n,) + src.shape[1:], dtype=src.dtype)
    return out.index_add_(0, seg, src)

def _pad(x, pw):
    flat = tuple((v for pair in reversed(pw) for v in pair))
    return torch.nn.functional.pad(x, flat)
kernel_name = 'standalone__conformer_conv_module__speech'

def setup_inputs():

    _w = lambda a: (lambda t: t.to(torch.bfloat16) if t.is_floating_point() else t)(torch.as_tensor(a))
    B, T, D, K = (2, 16000, 256, 31)
    return {'x': _w((lambda *s: torch.randn(*s, dtype=torch.bfloat16) * 0.2)(B, T, D)), 'w_pw1': _w((lambda *s: torch.randn(*s, dtype=torch.bfloat16) * 0.2)(D, 2 * D)), 'dw': _w((lambda *s: torch.randn(*s, dtype=torch.bfloat16) * 0.2)(K, D)), 'w_pw2': _w((lambda *s: torch.randn(*s, dtype=torch.bfloat16) * 0.05)(D, D))}

def reference(x, w_pw1, dw, w_pw2):
    B, T, D = x.shape
    K = dw.shape[0]
    h = x @ w_pw1
    a, b = (h[..., :D].clone(), h[..., D:].clone())
    h = a * _sigmoid(b)
    pad = K // 2
    hp = _pad(h, ((0, 0), (pad, pad), (0, 0)))
    out = torch.zeros_like(h)
    for i in range(K):
        out = out + hp[:, i:i + T, :] * dw[i][None, None, :]
    return _silu(out) @ w_pw2
```

```asm
; @launch grid=(256,1,1) block=(512,1,1) lds=163840
.amdgcn_target "amdgcn-amd-amdhsa--gfx950"
.text
.globl standalone__conformer_conv_module__speech_kernel
.p2align 8
.type standalone__conformer_conv_module__speech_kernel,@function
standalone__conformer_conv_module__speech_kernel:
    s_cmp_ge_u32 s2, 256
    s_cbranch_scc1 L_end
    s_load_dwordx2 s[4:5], s[0:1], 0
    s_load_dwordx2 s[8:9], s[0:1], 8
    s_load_dwordx2 s[12:13], s[0:1], 16
    s_load_dwordx2 s[16:17], s[0:1], 24
    s_load_dwordx2 s[20:21], s[0:1], 32
    s_load_dwordx2 s[28:29], s[0:1], 40
    s_load_dwordx2 s[24:25], s[0:1], 48
    s_lshr_b32 s3, s2, 3
    s_cmp_eq_u32 s3, 16
    s_cselect_b32 s3, 4, 0
    s_xor_b32 s2, s2, s3
    s_sub_u32 s2, s2, 4
    s_cbranch_scc1 L_helper
    v_lshrrev_b32 v46, 6, v0
    v_and_b32 v44, 63, v0
    v_readfirstlane_b32 s32, v46
    v_lshrrev_b32 v45, 5, v44
    s_lshl_b32 s34, s32, 6
    v_xor_b32 v46, v44, v45
    v_lshlrev_b32 v6, 4, v46
    v_and_b32 v48, 3, v44
    v_lshlrev_b32 v49, 4, v48
    v_add_u32 v50, s34, v49
    v_lshrrev_b32 v47, 2, v44
    v_bfe_u32 v53, v44, 4, 1
    v_and_b32 v54, 3, v47
    v_lshl_or_b32 v54, v45, 3, v54
    v_lshl_or_b32 v54, v53, 5, v54
    v_lshlrev_b32 v53, 5, v53
    v_xor_b32 v53, v53, v50
    v_lshl_add_u32 v7, v54, 10, v53
    v_lshl_add_u32 v51, v47, 9, v50
    v_and_b32 v51, 0xfffffeff, v51
    v_add_u32 v52, 8192, v51
    s_cmp_ge_u32 s2, 126
    s_cselect_b32 s34, 8192000, 0
    s_cselect_b32 s50, 126, 0
    s_sub_u32 s50, s2, s50
    s_lshl_b32 s35, s50, 16
    s_and_b32 s3, s32, 3
    s_lshl_b32 s39, s3, 12
    s_add_u32 s33, s39, s35
    s_sub_u32 s33, s33, 8192
    s_add_u32 s39, s39, 51712
    s_mul_i32 s41, s3, 4224
    s_mul_i32 s40, s3, 9216
    s_add_u32 s40, s40, 117248
    s_mov_b32 s6, 8192000
    s_mov_b32 s7, 0x20000
    s_mov_b32 s10, 262144
    s_mov_b32 s11, 0x20000
    s_mov_b32 s14, 15872
    s_mov_b32 s15, 0x20000
    s_add_u32 s35, s34, s35
    s_lshl_b32 s36, s3, 12
    s_add_u32 s36, s36, s33
    s_mul_i32 s51, s3, 4352
    v_lshrrev_b32 v68, 4, v44
    v_xor_b32 v69, v44, v68
    v_and_b32 v69, 15, v69
    v_lshlrev_b32 v69, 4, v69
    v_lshl_add_u32 v68, v68, 9, v69
    v_add_u32 v100, s36, v68
    v_add_u32 v101, 2048, v100
    v_add_u32 v102, 4096, v100
    v_add_u32 v103, 6144, v100
    s_bfe_u32 s36, s2, 0x40003
    s_lshl_b32 s36, s36, 14
    v_lshl_add_u32 v55, v0, 6, s36
    v_and_b32 v55, 0xfffffeff, v55
    s_waitcnt lgkmcnt(0)
    s_add_u32 s4, s4, s34
    s_addc_u32 s5, s5, 0
    s_setprio 2
    s_cmp_ge_u32 s32, 4
    s_cbranch_scc1 L_pF
    buffer_load_dword v254, v55, s[8:11], 0 offen
    s_add_u32 m0, s51, 0
    s_nop 0
    buffer_load_dwordx4 v100, s[4:7], 0 offen offset:0 nt lds
    s_add_u32 m0, s51, 1088
    s_nop 0
    buffer_load_dwordx4 v101, s[4:7], 0 offen offset:0 nt lds
    s_add_u32 m0, s51, 2176
    s_nop 0
    buffer_load_dwordx4 v102, s[4:7], 0 offen offset:0 nt lds
    s_add_u32 m0, s51, 3264
    s_nop 0
    buffer_load_dwordx4 v103, s[4:7], 0 offen offset:0 nt lds
    s_add_u32 m0, s39, 0
    s_mov_b32 s38, 0
    buffer_load_dwordx4 v7, s[8:11], s38 offen offset:0 lds
    s_add_u32 m0, s39, 512
    s_nop 0
    buffer_load_dwordx4 v7, s[8:11], s38 offen offset:512 lds
    s_branch L_p4
L_pF:
    s_getpc_b64 s[44:45]
L_pcF:
    s_mov_b32 s46, L_code_end-L_pcF
    s_mov_b32 s47, 0x20000
    s_bfe_u32 s34, s2, 0x30003
    s_lshl_b32 s34, s34, 12
    s_sub_u32 s34, s34, 4096
    v_lshl_add_u32 v53, v0, 4, s34
    buffer_load_dword v255, v53, s[44:47], 0 offen
    s_bfe_u32 s34, s2, 0x40003
    s_lshl_b32 s34, s34, 10
    s_sub_u32 s34, s34, 1024
    v_lshl_add_u32 v53, v0, 2, s34
    buffer_load_dword v253, v53, s[12:15], 0 offen
L_p4:
    s_setprio 0
    s_add_u32 s20, s20, s35
    s_addc_u32 s21, s21, 0
    s_mov_b32 s22, 65536
    s_mov_b32 s23, 0x20000
    s_mov_b32 s26, 0x10000000
    s_mov_b32 s27, 0x20000
    s_mov_b32 s30, 256
    s_mov_b32 s31, 0x20000
    s_mul_i32 s48, s3, 2320
    s_add_u32 s48, s48, 154112
    v_bfe_u32 v53, v44, 2, 2
    v_lshlrev_b32 v53, 6, v53
    v_lshl_or_b32 v53, v45, 9, v53
    v_bfe_u32 v57, v44, 4, 1
    v_lshl_or_b32 v53, v57, 5, v53
    v_lshl_or_b32 v56, v48, 3, v53
    s_lshl_b32 s0, 1, s32
    s_mov_b32 s1, 0
    s_add_u32 s34, s39, 32768
    s_mov_b32 s35, 16384
    v_and_b32 v53, 1, v48
    v_mul_u32_u24 v53, 72, v53
    v_lshrrev_b32 v54, 1, v48
    v_lshl_add_u32 v53, v54, 2, v53
    v_mul_u32_u24 v54, 144, v47
    v_sub_u32 v54, v54, v53
    s_add_u32 s34, s34, 76
    v_add_u32 v42, s34, v54
    v_add_u32 v43, s35, v42
    s_cmp_lt_u32 s32, 4
    s_cbranch_scc1 L_notab
    v_mov_b32 v6, v42
    v_bfe_u32 v53, v44, 2, 2
    v_and_b32 v54, 13, v44
    v_bcnt_u32_b32 v54, v54, 0
    v_and_b32 v54, 1, v54
    v_lshl_or_b32 v54, v53, 1, v54
    v_bfe_u32 v53, v44, 1, 1
    v_lshl_or_b32 v54, v53, 3, v54
    v_mul_u32_u24 v54, 144, v54
    v_mul_u32_u24 v104, 15232, v53
    s_add_u32 s34, s39, 32768
    v_lshl_add_u32 v53, v57, 14, v54
    v_add_u32 v58, s34, v53
    s_sub_u32 s35, s48, s34
    v_add_u32 v65, s35, v42
    v_mul_u32_u24 v53, 15232, v45
    v_add_u32 v53, 2304, v53
    v_add_u32 v64, v53, v42
    s_add_u32 s34, s34, 2304
    v_add_u32 v104, s34, v104
    v_cmp_eq_u32 vcc, 0, v57
    v_mov_b32 v53, s48
    s_add_u32 s34, s40, 4608
    v_cndmask_b32 v104, v53, v104, vcc
    v_add_u32 v104, v54, v104
    v_mov_b32 v59, 0
    v_and_b32 v53, 15, v44
    v_lshl_add_u32 v66, v53, 2, s34
    v_lshlrev_b32 v53, 2, v44
    v_add_u32 v67, 163392, v53
    v_cmp_eq_u32 vcc, 0, v45
    v_lshlrev_b32 v54, 4, v45
    v_lshl_add_u32 v54, v57, 3, v54
    v_cndmask_b32 v106, v104, v58, vcc
    v_add_u32 v60, v54, v58
    v_xor_b32 v61, 8, v60
    v_add_u32 v104, v54, v104
    v_xor_b32 v105, 8, v104
    v_lshlrev_b32 v53, 8, v57
    v_add3_u32 v62, v53, v56, s34
    v_xor_b32 v63, 256, v62
L_notab:
    s_mov_b32 s36, 0xbf317218
    s_mov_b32 s37, 0xbfb8aa3b
    v_bfe_u32 v46, v44, 2, 3
    v_bcnt_u32_b32 v46, v46, 0
    v_and_b32 v46, 1, v46
    v_lshl_or_b32 v46, v45, 1, v46
    v_bfe_u32 v53, v44, 3, 2
    v_lshl_or_b32 v46, v53, 2, v46
    s_sub_u32 s34, s40, 64
    v_mul_u32_u24 v53, 144, v46
    v_add3_u32 v3, v53, v49, s34
    v_lshrrev_b32 v50, 4, v44
    v_and_b32 v53, 15, v44
    v_mul_u32_u24 v53, 144, v53
    v_lshlrev_b32 v54, 4, v50
    v_add3_u32 v2, v53, v54, s40
    v_lshlrev_b32 v53, 1, v57
    v_xor_b32 v53, v53, v44
    v_lshl_add_u32 v4, v53, 4, s39
    v_lshlrev_b32 v53, 6, v47
    v_lshl_or_b32 v53, v57, 5, v53
    v_lshl_or_b32 v53, v48, 3, v53
    v_add_u32 v1, 51712, v53
    v_add_u32 v124, s39, v53
    v_xor_b32 v125, 32, v124
    v_add_u32 v126, s40, v53
    v_xor_b32 v41, 32, v126
    v_bfe_u32 v53, v44, 2, 2
    v_mul_u32_u24 v54, 2176, v53
    v_lshl_add_u32 v54, v48, 8, v54
    v_lshl_add_u32 v54, v57, 6, v54
    v_xor_b32 v46, v48, v45
    v_lshl_add_u32 v127, v46, 4, v54
    v_xor_b32 v5, 32, v127
    v_bfe_u32 v54, v44, 1, 1
    v_lshl_or_b32 v53, v53, 2, v54
    v_mul_u32_u24 v53, 1056, v53
    v_and_b32 v54, 1, v44
    v_lshl_add_u32 v53, v54, 9, v53
    v_lshl_add_u32 v53, v57, 6, v53
    v_and_b32 v46, 1, v46
    v_lshl_add_u32 v0, v46, 4, v53
    s_mov_b32 s42, 0x88888888
    s_mov_b32 s43, 0x88888888
    s_mov_b32 s44, 0xcccccccc
    s_mov_b32 s45, 0xcccccccc
    s_mov_b32 s46, 0xeeeeeeee
    s_mov_b32 s47, 0xeeeeeeee
    s_lshl_b32 s49, s2, 14
    s_add_u32 s49, s49, 996864
    s_cmp_ge_u32 s32, 4
    s_cbranch_scc1 L_F
    s_add_u32 m0, s39, 16384
    s_mov_b32 s38, 4096
    buffer_load_dwordx4 v7, s[8:11], s38 offen offset:0 lds
    s_add_u32 m0, s39, 16896
    s_nop 0
    buffer_load_dwordx4 v7, s[8:11], s38 offen offset:512 lds
    s_add_u32 m0, s40, 0
    s_mov_b32 s38, 16384
    buffer_load_dwordx4 v7, s[8:11], s38 offen offset:0 lds
    s_add_u32 m0, s40, 512
    s_nop 0
    buffer_load_dwordx4 v7, s[8:11], s38 offen offset:512 lds
    s_add_u32 m0, s40, 2048
    s_mov_b32 s38, 20480
    buffer_load_dwordx4 v7, s[8:11], s38 offen offset:0 lds
    s_add_u32 m0, s40, 2560
    s_nop 0
    buffer_load_dwordx4 v7, s[8:11], s38 offen offset:512 lds
    s_setprio 2
    s_waitcnt vmcnt(8)
    s_barrier
    s_add_u32 m0, s39, 2048
    s_mov_b32 s38, 65536
    buffer_load_dwordx4 v7, s[8:11], s38 offen offset:0 lds
    s_add_u32 m0, s39, 2560
    s_nop 0
    buffer_load_dwordx4 v7, s[8:11], s38 offen offset:512 lds
    s_add_u32 m0, s39, 18432
    s_mov_b32 s38, 69632
    buffer_load_dwordx4 v7, s[8:11], s38 offen offset:0 lds
    s_add_u32 m0, s39, 18944
    s_nop 0
    buffer_load_dwordx4 v7, s[8:11], s38 offen offset:512 lds
    ds_read_b128 v[108:111], v127 offset:0
    ds_read_b128 v[112:115], v5 offset:0
    ds_read_b128 v[116:119], v127 offset:8704
    ds_read_b128 v[120:123], v5 offset:8704
    s_waitcnt vmcnt(10)
    ds_read_b64_tr_b16 v[136:137], v124 offset:1024
    ds_read_b64_tr_b16 v[140:141], v125 offset:1024
    ds_read_b64_tr_b16 v[128:129], v124 offset:0
    ds_read_b64_tr_b16 v[132:133], v125 offset:0
    s_waitcnt vmcnt(8)
    ds_read_b64_tr_b16 v[138:139], v124 offset:17408
    ds_read_b64_tr_b16 v[142:143], v125 offset:17408
    ds_read_b64_tr_b16 v[130:131], v124 offset:16384
    ds_read_b64_tr_b16 v[134:135], v125 offset:16384
    s_waitcnt vmcnt(6)
    ds_read_b64_tr_b16 v[152:153], v126 offset:1024
    ds_read_b64_tr_b16 v[156:157], v41 offset:1024
    ds_read_b64_tr_b16 v[144:145], v126 offset:0
    ds_read_b64_tr_b16 v[148:149], v41 offset:0
    s_waitcnt lgkmcnt(4)
    s_add_u32 m0, s39, 0
    s_mov_b32 s38, 81920
    buffer_load_dwordx4 v7, s[8:11], s38 offen offset:0 lds
    s_add_u32 m0, s39, 512
    s_nop 0
    buffer_load_dwordx4 v7, s[8:11], s38 offen offset:512 lds
    s_waitcnt vmcnt(6)
    ds_read_b64_tr_b16 v[154:155], v126 offset:3072
    ds_read_b64_tr_b16 v[158:159], v41 offset:3072
    ds_read_b64_tr_b16 v[146:147], v126 offset:2048
    ds_read_b64_tr_b16 v[150:151], v41 offset:2048
    s_add_u32 m0, s39, 16384
    s_mov_b32 s38, 86016
    buffer_load_dwordx4 v7, s[8:11], s38 offen offset:0 lds
    s_add_u32 m0, s39, 16896
    s_nop 0
    buffer_load_dwordx4 v7, s[8:11], s38 offen offset:512 lds
    s_add_u32 m0, s40, 0
    s_mov_b32 s38, 131072
    s_waitcnt lgkmcnt(0)
    v_mfma_f32_16x16x32_bf16 v[92:95], v[108:111], v[136:139], 0
    s_waitcnt vmcnt(6)
    ds_read_b64_tr_b16 v[168:169], v124 offset:3072
    v_mfma_f32_16x16x32_bf16 v[92:95], v[112:115], v[152:155], v[92:95]
    ds_read_b64_tr_b16 v[172:173], v125 offset:3072
    ds_read_b64_tr_b16 v[160:161], v124 offset:2048
    v_mfma_f32_16x16x32_bf16 v[100:103], v[108:111], v[140:143], 0
    ds_read_b64_tr_b16 v[164:165], v125 offset:2048
    v_mfma_f32_16x16x32_bf16 v[100:103], v[112:115], v[156:159], v[100:103]
    buffer_load_dwordx4 v7, s[8:11], s38 offen offset:0 lds
    v_mfma_f32_16x16x32_bf16 v[76:79], v[108:111], v[128:131], 0
    s_add_u32 m0, s40, 512
    v_mfma_f32_16x16x32_bf16 v[76:79], v[112:115], v[144:147], v[76:79]
    buffer_load_dwordx4 v7, s[8:11], s38 offen offset:512 lds
    v_mfma_f32_16x16x32_bf16 v[84:87], v[108:111], v[132:135], 0
    ds_read_b128 v[108:111], v127 offset:1088
    s_add_u32 m0, s40, 2048
    v_mfma_f32_16x16x32_bf16 v[84:87], v[112:115], v[148:151], v[84:87]
    ds_read_b128 v[112:115], v5 offset:1088
    v_mfma_f32_16x16x32_bf16 v[60:63], v[116:119], v[136:139], 0
    s_waitcnt vmcnt(6)
    ds_read_b64_tr_b16 v[170:171], v124 offset:19456
    v_mfma_f32_16x16x32_bf16 v[60:63], v[120:123], v[152:155], v[60:63]
    ds_read_b64_tr_b16 v[174:175], v125 offset:19456
    ds_read_b64_tr_b16 v[162:163], v124 offset:18432
    v_mfma_f32_16x16x32_bf16 v[68:71], v[116:119], v[140:143], 0
    ds_read_b64_tr_b16 v[166:167], v125 offset:18432
    s_mov_b32 s38, 135168
    v_mfma_f32_16x16x32_bf16 v[68:71], v[120:123], v[156:159], v[68:71]
    buffer_load_dwordx4 v7, s[8:11], s38 offen offset:0 lds
    v_mfma_f32_16x16x32_bf16 v[44:47], v[116:119], v[128:131], 0
    s_add_u32 m0, s40, 2560
    v_mfma_f32_16x16x32_bf16 v[44:47], v[120:123], v[144:147], v[44:47]
    buffer_load_dwordx4 v7, s[8:11], s38 offen offset:512 lds
    v_mfma_f32_16x16x32_bf16 v[52:55], v[116:119], v[132:135], 0
    ds_read_b128 v[116:119], v127 offset:9792
    s_add_u32 m0, s39, 2048
    v_mfma_f32_16x16x32_bf16 v[52:55], v[120:123], v[148:151], v[52:55]
    ds_read_b128 v[120:123], v5 offset:9792
    s_waitcnt lgkmcnt(6)
    v_mfma_f32_16x16x32_bf16 v[96:99], v[108:111], v[136:139], 0
    s_waitcnt vmcnt(6)
    ds_read_b64_tr_b16 v[184:185], v124 offset:1024
    v_mfma_f32_16x16x32_bf16 v[96:99], v[112:115], v[152:155], v[96:99]
    ds_read_b64_tr_b16 v[188:189], v125 offset:1024
    ds_read_b64_tr_b16 v[176:177], v124 offset:0
    v_mfma_f32_16x16x32_bf16 v[104:107], v[108:111], v[140:143], 0
    ds_read_b64_tr_b16 v[180:181], v125 offset:0
    s_mov_b32 s38, 147456
    v_mfma_f32_16x16x32_bf16 v[104:107], v[112:115], v[156:159], v[104:107]
    buffer_load_dwordx4 v7, s[8:11], s38 offen offset:0 lds
    v_mfma_f32_16x16x32_bf16 v[80:83], v[108:111], v[128:131], 0
    s_add_u32 m0, s39, 2560
    v_mfma_f32_16x16x32_bf16 v[80:83], v[112:115], v[144:147], v[80:83]
    buffer_load_dwordx4 v7, s[8:11], s38 offen offset:512 lds
    v_mfma_f32_16x16x32_bf16 v[88:91], v[108:111], v[132:135], 0
    ds_read_b128 v[108:111], v127 offset:128
    s_add_u32 m0, s39, 18432
    v_mfma_f32_16x16x32_bf16 v[88:91], v[112:115], v[148:151], v[88:91]
    ds_read_b128 v[112:115], v5 offset:128
    s_waitcnt lgkmcnt(6)
    v_mfma_f32_16x16x32_bf16 v[64:67], v[116:119], v[136:139], 0
    s_waitcnt vmcnt(6)
    ds_read_b64_tr_b16 v[186:187], v124 offset:17408
    v_mfma_f32_16x16x32_bf16 v[64:67], v[120:123], v[152:155], v[64:67]
    ds_read_b64_tr_b16 v[190:191], v125 offset:17408
    ds_read_b64_tr_b16 v[178:179], v124 offset:16384
    v_mfma_f32_16x16x32_bf16 v[72:75], v[116:119], v[140:143], 0
    ds_read_b64_tr_b16 v[182:183], v125 offset:16384
    s_mov_b32 s38, 151552
    v_mfma_f32_16x16x32_bf16 v[72:75], v[120:123], v[156:159], v[72:75]
    buffer_load_dwordx4 v7, s[8:11], s38 offen offset:0 lds
    v_mfma_f32_16x16x32_bf16 v[48:51], v[116:119], v[128:131], 0
    s_add_u32 m0, s39, 18944
    v_mfma_f32_16x16x32_bf16 v[48:51], v[120:123], v[144:147], v[48:51]
    buffer_load_dwordx4 v7, s[8:11], s38 offen offset:512 lds
    v_mfma_f32_16x16x32_bf16 v[56:59], v[116:119], v[132:135], 0
    ds_read_b128 v[116:119], v127 offset:8832
    s_add_u32 m0, s39, 0
    v_mfma_f32_16x16x32_bf16 v[56:59], v[120:123], v[148:151], v[56:59]
    ds_read_b128 v[120:123], v5 offset:8832
    s_waitcnt lgkmcnt(2)
    v_mfma_f32_16x16x32_bf16 v[92:95], v[108:111], v[168:171], v[92:95]
    s_waitcnt vmcnt(6)
    ds_read_b64_tr_b16 v[200:201], v126 offset:1024
    v_mfma_f32_16x16x32_bf16 v[92:95], v[112:115], v[184:187], v[92:95]
    ds_read_b64_tr_b16 v[204:205], v41 offset:1024
    ds_read_b64_tr_b16 v[192:193], v126 offset:0
    v_mfma_f32_16x16x32_bf16 v[100:103], v[108:111], v[172:175], v[100:103]
    ds_read_b64_tr_b16 v[196:197], v41 offset:0
    s_mov_b32 s38, 196608
    v_mfma_f32_16x16x32_bf16 v[100:103], v[112:115], v[188:191], v[100:103]
    buffer_load_dwordx4 v7, s[8:11], s38 offen offset:0 lds
    v_mfma_f32_16x16x32_bf16 v[76:79], v[108:111], v[160:163], v[76:79]
    s_add_u32 m0, s39, 512
    v_mfma_f32_16x16x32_bf16 v[76:79], v[112:115], v[176:179], v[76:79]
    buffer_load_dwordx4 v7, s[8:11], s38 offen offset:512 lds
    v_mfma_f32_16x16x32_bf16 v[84:87], v[108:111], v[164:167], v[84:87]
    ds_read_b128 v[108:111], v127 offset:1216
    s_add_u32 m0, s39, 16384
    v_mfma_f32_16x16x32_bf16 v[84:87], v[112:115], v[180:183], v[84:87]
    ds_read_b128 v[112:115], v5 offset:1216
    s_waitcnt lgkmcnt(6)
    v_mfma_f32_16x16x32_bf16 v[60:63], v[116:119], v[168:171], v[60:63]
    s_waitcnt vmcnt(6)
    ds_read_b64_tr_b16 v[202:203], v126 offset:3072
    v_mfma_f32_16x16x32_bf16 v[60:63], v[120:123], v[184:187], v[60:63]
    ds_read_b64_tr_b16 v[206:207], v41 offset:3072
    ds_read_b64_tr_b16 v[194:195], v126 offset:2048
    v_mfma_f32_16x16x32_bf16 v[68:71], v[116:119], v[172:175], v[68:71]
    ds_read_b64_tr_b16 v[198:199], v41 offset:2048
    s_mov_b32 s38, 200704
    v_mfma_f32_16x16x32_bf16 v[68:71], v[120:123], v[188:191], v[68:71]
    buffer_load_dwordx4 v7, s[8:11], s38 offen offset:0 lds
    v_mfma_f32_16x16x32_bf16 v[44:47], v[116:119], v[160:163], v[44:47]
    s_add_u32 m0, s39, 16896
    v_mfma_f32_16x16x32_bf16 v[44:47], v[120:123], v[176:179], v[44:47]
    buffer_load_dwordx4 v7, s[8:11], s38 offen offset:512 lds
    v_mfma_f32_16x16x32_bf16 v[52:55], v[116:119], v[164:167], v[52:55]
    ds_read_b128 v[116:119], v127 offset:9920
    s_add_u32 m0, s40, 0
    v_mfma_f32_16x16x32_bf16 v[52:55], v[120:123], v[180:183], v[52:55]
    ds_read_b128 v[120:123], v5 offset:9920
    s_waitcnt lgkmcnt(6)
    v_mfma_f32_16x16x32_bf16 v[96:99], v[108:111], v[168:171], v[96:99]
    s_waitcnt vmcnt(6)
    ds_read_b64_tr_b16 v[216:217], v124 offset:3072
    v_mfma_f32_16x16x32_bf16 v[96:99], v[112:115], v[184:187], v[96:99]
    ds_read_b64_tr_b16 v[220:221], v125 offset:3072
    ds_read_b64_tr_b16 v[208:209], v124 offset:2048
    s_barrier
    v_mfma_f32_16x16x32_bf16 v[104:107], v[108:111], v[172:175], v[104:107]
    ds_read_b64_tr_b16 v[212:213], v125 offset:2048
    s_mov_b32 s38, 212992
    v_mfma_f32_16x16x32_bf16 v[104:107], v[112:115], v[188:191], v[104:107]
    buffer_load_dwordx4 v7, s[8:11], s38 offen offset:0 lds
    v_mfma_f32_16x16x32_bf16 v[80:83], v[108:111], v[160:163], v[80:83]
    s_add_u32 m0, s40, 512
    v_mfma_f32_16x16x32_bf16 v[80:83], v[112:115], v[176:179], v[80:83]
    buffer_load_dwordx4 v7, s[8:11], s38 offen offset:512 lds
    v_mfma_f32_16x16x32_bf16 v[88:91], v[108:111], v[164:167], v[88:91]
    s_add_u32 m0, s40, 2048
    v_mfma_f32_16x16x32_bf16 v[88:91], v[112:115], v[180:183], v[88:91]
    s_waitcnt lgkmcnt(4)
    v_mfma_f32_16x16x32_bf16 v[64:67], v[116:119], v[168:171], v[64:67]
    s_waitcnt vmcnt(6)
    ds_read_b64_tr_b16 v[218:219], v124 offset:19456
    v_mfma_f32_16x16x32_bf16 v[64:67], v[120:123], v[184:187], v[64:67]
    ds_read_b64_tr_b16 v[222:223], v125 offset:19456
    ds_read_b64_tr_b16 v[210:211], v124 offset:18432
    v_mfma_f32_16x16x32_bf16 v[72:75], v[116:119], v[172:175], v[72:75]
    ds_read_b64_tr_b16 v[214:215], v125 offset:18432
    s_mov_b32 s38, 217088
    v_mfma_f32_16x16x32_bf16 v[72:75], v[120:123], v[188:191], v[72:75]
    buffer_load_dwordx4 v7, s[8:11], s38 offen offset:0 lds
    v_mfma_f32_16x16x32_bf16 v[48:51], v[116:119], v[160:163], v[48:51]
    s_add_u32 m0, s40, 2560
    v_mfma_f32_16x16x32_bf16 v[48:51], v[120:123], v[176:179], v[48:51]
    buffer_load_dwordx4 v7, s[8:11], s38 offen offset:512 lds
    v_mfma_f32_16x16x32_bf16 v[56:59], v[116:119], v[164:167], v[56:59]
    v_mfma_f32_16x16x32_bf16 v[56:59], v[120:123], v[180:183], v[56:59]
    s_barrier
    s_setprio 3
    ds_read_b128 v[108:111], v127 offset:17408
    ds_read_b128 v[112:115], v5 offset:17408
    ds_read_b128 v[116:119], v127 offset:26112
    ds_read_b128 v[120:123], v5 offset:26112
    s_waitcnt lgkmcnt(2)
    v_mfma_f32_16x16x32_bf16 v[92:95], v[108:111], v[200:203], v[92:95]
    s_waitcnt vmcnt(6)
    ds_read_b64_tr_b16 v[232:233], v124 offset:1024
    v_mfma_f32_16x16x32_bf16 v[92:95], v[112:115], v[216:219], v[92:95]
    ds_read_b64_tr_b16 v[236:237], v125 offset:1024
    ds_read_b64_tr_b16 v[224:225], v124 offset:0
    v_mfma_f32_16x16x32_bf16 v[100:103], v[108:111], v[204:207], v[100:103]
    ds_read_b64_tr_b16 v[228:229], v125 offset:0
    v_mfma_f32_16x16x32_bf16 v[100:103], v[112:115], v[220:223], v[100:103]
    v_mfma_f32_16x16x32_bf16 v[76:79], v[108:111], v[192:195], v[76:79]
    v_mfma_f32_16x16x32_bf16 v[76:79], v[112:115], v[208:211], v[76:79]
    v_mfma_f32_16x16x32_bf16 v[84:87], v[108:111], v[196:199], v[84:87]
    ds_read_b128 v[108:111], v127 offset:18496
    v_mfma_f32_16x16x32_bf16 v[84:87], v[112:115], v[212:215], v[84:87]
    ds_read_b128 v[112:115], v5 offset:18496
    s_waitcnt lgkmcnt(6)
    v_mfma_f32_16x16x32_bf16 v[60:63], v[116:119], v[200:203], v[60:63]
    s_waitcnt vmcnt(4)
    ds_read_b64_tr_b16 v[234:235], v124 offset:17408
    s_waitcnt lgkmcnt(0)
    s_barrier
    v_mfma_f32_16x16x32_bf16 v[60:63], v[120:123], v[216:219], v[60:63]
    ds_read_b64_tr_b16 v[238:239], v125 offset:17408
    ds_read_b64_tr_b16 v[226:227], v124 offset:16384
    v_mfma_f32_16x16x32_bf16 v[68:71], v[116:119], v[204:207], v[68:71]
    ds_read_b64_tr_b16 v[230:231], v125 offset:16384
    v_mfma_f32_16x16x32_bf16 v[68:71], v[120:123], v[220:223], v[68:71]
    v_mfma_f32_16x16x32_bf16 v[44:47], v[116:119], v[192:195], v[44:47]
    v_mfma_f32_16x16x32_bf16 v[44:47], v[120:123], v[208:211], v[44:47]
    v_mfma_f32_16x16x32_bf16 v[52:55], v[116:119], v[196:199], v[52:55]
    ds_read_b128 v[116:119], v127 offset:27200
    v_mfma_f32_16x16x32_bf16 v[52:55], v[120:123], v[212:215], v[52:55]
    ds_read_b128 v[120:123], v5 offset:27200
    v_mfma_f32_16x16x32_bf16 v[96:99], v[108:111], v[200:203], v[96:99]
    s_waitcnt vmcnt(2)
    ds_read_b64_tr_b16 v[248:249], v126 offset:1024
    v_mfma_f32_16x16x32_bf16 v[96:99], v[112:115], v[216:219], v[96:99]
    ds_read_b64_tr_b16 v[252:253], v41 offset:1024
    ds_read_b64_tr_b16 v[240:241], v126 offset:0
    v_mfma_f32_16x16x32_bf16 v[104:107], v[108:111], v[204:207], v[104:107]
    ds_read_b64_tr_b16 v[244:245], v41 offset:0
    v_mfma_f32_16x16x32_bf16 v[104:107], v[112:115], v[220:223], v[104:107]
    v_mfma_f32_16x16x32_bf16 v[80:83], v[108:111], v[192:195], v[80:83]
    ds_read2_b32 v[8:9], v42 offset0:0 offset1:1
    ds_read2_b32 v[10:11], v42 offset0:2 offset1:3
    v_mfma_f32_16x16x32_bf16 v[80:83], v[112:115], v[208:211], v[80:83]
    v_mfma_f32_16x16x32_bf16 v[88:91], v[108:111], v[196:199], v[88:91]
    ds_read_b128 v[108:111], v127 offset:17536
    v_mfma_f32_16x16x32_bf16 v[88:91], v[112:115], v[212:215], v[88:91]
    ds_read_b128 v[112:115], v5 offset:17536
    s_waitcnt lgkmcnt(8)
    v_mfma_f32_16x16x32_bf16 v[64:67], v[116:119], v[200:203], v[64:67]
    s_waitcnt vmcnt(0)
    ds_read_b64_tr_b16 v[250:251], v126 offset:3072
    ds_read2_b32 v[12:13], v42 offset0:4 offset1:5
    ds_read2_b32 v[14:15], v42 offset0:6 offset1:7
    v_mfma_f32_16x16x32_bf16 v[64:67], v[120:123], v[216:219], v[64:67]
    ds_read_b64_tr_b16 v[254:255], v41 offset:3072
    ds_read_b64_tr_b16 v[242:243], v126 offset:2048
    v_mfma_f32_16x16x32_bf16 v[72:75], v[116:119], v[204:207], v[72:75]
    ds_read_b64_tr_b16 v[246:247], v41 offset:2048
    v_mfma_f32_16x16x32_bf16 v[72:75], v[120:123], v[220:223], v[72:75]
    v_mfma_f32_16x16x32_bf16 v[48:51], v[116:119], v[192:195], v[48:51]
    ds_read2_b32 v[16:17], v42 offset0:8 offset1:9
    ds_read2_b32 v[18:19], v42 offset0:10 offset1:11
    v_mfma_f32_16x16x32_bf16 v[48:51], v[120:123], v[208:211], v[48:51]
    v_mfma_f32_16x16x32_bf16 v[56:59], v[116:119], v[196:199], v[56:59]
    ds_read_b128 v[116:119], v127 offset:26240
    v_mfma_f32_16x16x32_bf16 v[56:59], v[120:123], v[212:215], v[56:59]
    ds_read_b128 v[120:123], v5 offset:26240
    s_waitcnt lgkmcnt(4)
    v_mfma_f32_16x16x32_bf16 v[92:95], v[108:111], v[232:235], v[92:95]
    ds_read2_b32 v[20:21], v42 offset0:12 offset1:13
    ds_read2_b32 v[22:23], v42 offset0:14 offset1:15
    v_mfma_f32_16x16x32_bf16 v[92:95], v[112:115], v[248:251], v[92:95]
    v_mfma_f32_16x16x32_bf16 v[100:103], v[108:111], v[236:239], v[100:103]
    v_mfma_f32_16x16x32_bf16 v[100:103], v[112:115], v[252:255], v[100:103]
    v_mfma_f32_16x16x32_bf16 v[76:79], v[108:111], v[224:227], v[76:79]
    ds_read2_b32 v[24:25], v42 offset0:16 offset1:17
    ds_read2_b32 v[26:27], v43 offset0:0 offset1:1
    v_mfma_f32_16x16x32_bf16 v[76:79], v[112:115], v[240:243], v[76:79]
    v_mfma_f32_16x16x32_bf16 v[84:87], v[108:111], v[228:231], v[84:87]
    ds_read_b128 v[108:111], v127 offset:18624
    v_mfma_f32_16x16x32_bf16 v[84:87], v[112:115], v[244:247], v[84:87]
    ds_read_b128 v[112:115], v5 offset:18624
    s_waitcnt lgkmcnt(6)
    v_mfma_f32_16x16x32_bf16 v[60:63], v[116:119], v[232:235], v[60:63]
    ds_read2_b32 v[28:29], v43 offset0:2 offset1:3
    ds_read2_b32 v[30:31], v43 offset0:4 offset1:5
    v_mfma_f32_16x16x32_bf16 v[60:63], v[120:123], v[248:251], v[60:63]
    v_mfma_f32_16x16x32_bf16 v[68:71], v[116:119], v[236:239], v[68:71]
    v_mfma_f32_16x16x32_bf16 v[68:71], v[120:123], v[252:255], v[68:71]
    v_mfma_f32_16x16x32_bf16 v[44:47], v[116:119], v[224:227], v[44:47]
    ds_read2_b32 v[32:33], v43 offset0:6 offset1:7
    ds_read2_b32 v[34:35], v43 offset0:8 offset1:9
    v_mfma_f32_16x16x32_bf16 v[44:47], v[120:123], v[240:243], v[44:47]
    v_mfma_f32_16x16x32_bf16 v[52:55], v[116:119], v[228:231], v[52:55]
    ds_read_b128 v[116:119], v127 offset:27328
    v_mfma_f32_16x16x32_bf16 v[52:55], v[120:123], v[244:247], v[52:55]
    ds_read_b128 v[120:123], v5 offset:27328
    s_waitcnt lgkmcnt(6)
    v_mfma_f32_16x16x32_bf16 v[96:99], v[108:111], v[232:235], v[96:99]
    ds_read2_b32 v[36:37], v43 offset0:10 offset1:11
    ds_read2_b32 v[38:39], v43 offset0:12 offset1:13
    v_mfma_f32_16x16x32_bf16 v[96:99], v[112:115], v[248:251], v[96:99]
    v_mfma_f32_16x16x32_bf16 v[104:107], v[108:111], v[236:239], v[104:107]
    v_mfma_f32_16x16x32_bf16 v[104:107], v[112:115], v[252:255], v[104:107]
    v_mfma_f32_16x16x32_bf16 v[80:83], v[108:111], v[224:227], v[80:83]
    ds_read2_b32 v[40:41], v43 offset0:14 offset1:15
    ds_read2_b32 v[42:43], v43 offset0:16 offset1:17
    v_mfma_f32_16x16x32_bf16 v[80:83], v[112:115], v[240:243], v[80:83]
    v_mfma_f32_16x16x32_bf16 v[88:91], v[108:111], v[228:231], v[88:91]
    v_mfma_f32_16x16x32_bf16 v[88:91], v[112:115], v[244:247], v[88:91]
    s_waitcnt lgkmcnt(4)
    v_mfma_f32_16x16x32_bf16 v[64:67], v[116:119], v[232:235], v[64:67]
    v_mfma_f32_16x16x32_bf16 v[64:67], v[120:123], v[248:251], v[64:67]
    v_mfma_f32_16x16x32_bf16 v[72:75], v[116:119], v[236:239], v[72:75]
    v_mfma_f32_16x16x32_bf16 v[72:75], v[120:123], v[252:255], v[72:75]
    v_mfma_f32_16x16x32_bf16 v[48:51], v[116:119], v[224:227], v[48:51]
    v_mfma_f32_16x16x32_bf16 v[48:51], v[120:123], v[240:243], v[48:51]
    v_mfma_f32_16x16x32_bf16 v[56:59], v[116:119], v[228:231], v[56:59]
    v_mfma_f32_16x16x32_bf16 v[56:59], v[120:123], v[244:247], v[56:59]
    s_setprio 0
    v_mul_f32 v92, s37, v92
    v_mul_f32 v93, s37, v93
    v_mul_f32 v94, s37, v94
    v_mul_f32 v95, s37, v95
    v_mul_f32 v96, s37, v96
    v_mul_f32 v97, s37, v97
    v_mul_f32 v98, s37, v98
    v_mul_f32 v99, s37, v99
    v_exp_f32 v92, v92
    v_exp_f32 v93, v93
    v_exp_f32 v94, v94
    v_exp_f32 v95, v95
    v_fma_f32 v92, v92, s36, s36
    v_fma_f32 v93, v93, s36, s36
    v_exp_f32 v96, v96
    v_exp_f32 v97, v97
    v_fma_f32 v94, v94, s36, s36
    v_fma_f32 v95, v95, s36, s36
    v_exp_f32 v98, v98
    v_exp_f32 v99, v99
    v_fma_f32 v96, v96, s36, s36
    v_fma_f32 v97, v97, s36, s36
    v_fma_f32 v98, v98, s36, s36
    v_fma_f32 v99, v99, s36, s36
    v_rcp_f32 v92, v92
    v_rcp_f32 v93, v93
    v_rcp_f32 v94, v94
    v_rcp_f32 v95, v95
    v_mul_f32 v92, v76, v92
    v_mul_f32 v93, v77, v93
    v_rcp_f32 v96, v96
    v_rcp_f32 v97, v97
    v_mul_f32 v94, v78, v94
    v_mul_f32 v95, v79, v95
    v_rcp_f32 v98, v98
    v_cvt_pk_bf16_f32 v76, v92, v93
    v_mul_f32 v96, v80, v96
    v_rcp_f32 v99, v99
    v_mul_f32 v97, v81, v97
    v_cvt_pk_bf16_f32 v77, v94, v95
    v_mul_f32 v98, v82, v98
    v_mul_f32 v99, v83, v99
    v_cvt_pk_bf16_f32 v78, v96, v97
    v_cvt_pk_bf16_f32 v79, v98, v99
    v_mul_f32 v100, s37, v100
    v_mul_f32 v101, s37, v101
    v_mul_f32 v102, s37, v102
    v_mul_f32 v103, s37, v103
    v_mul_f32 v104, s37, v104
    v_mul_f32 v105, s37, v105
    v_mul_f32 v106, s37, v106
    v_mul_f32 v107, s37, v107
    v_exp_f32 v100, v100
    v_exp_f32 v101, v101
    v_exp_f32 v102, v102
    v_exp_f32 v103, v103
    v_fma_f32 v100, v100, s36, s36
    v_fma_f32 v101, v101, s36, s36
    v_exp_f32 v104, v104
    v_exp_f32 v105, v105
    v_fma_f32 v102, v102, s36, s36
    v_fma_f32 v103, v103, s36, s36
    v_exp_f32 v106, v106
    v_exp_f32 v107, v107
    v_fma_f32 v104, v104, s36, s36
    v_fma_f32 v105, v105, s36, s36
    v_fma_f32 v106, v106, s36, s36
    v_fma_f32 v107, v107, s36, s36
    v_rcp_f32 v100, v100
    v_rcp_f32 v101, v101
    v_rcp_f32 v102, v102
    v_rcp_f32 v103, v103
    v_mul_f32 v100, v84, v100
    v_mul_f32 v101, v85, v101
    v_rcp_f32 v104, v104
    v_rcp_f32 v105, v105
    v_mul_f32 v102, v86, v102
    v_mul_f32 v103, v87, v103
    v_rcp_f32 v106, v106
    v_cvt_pk_bf16_f32 v84, v100, v101
    v_mul_f32 v104, v88, v104
    v_rcp_f32 v107, v107
    v_mul_f32 v105, v89, v105
    v_cvt_pk_bf16_f32 v85, v102, v103
    v_mul_f32 v106, v90, v106
    v_mul_f32 v107, v91, v107
    v_cvt_pk_bf16_f32 v86, v104, v105
    v_cvt_pk_bf16_f32 v87, v106, v107
    v_mul_f32 v60, s37, v60
    v_mul_f32 v61, s37, v61
    v_mul_f32 v62, s37, v62
    v_mul_f32 v63, s37, v63
    v_mul_f32 v64, s37, v64
    v_mul_f32 v65, s37, v65
    v_mul_f32 v66, s37, v66
    v_mul_f32 v67, s37, v67
    v_exp_f32 v60, v60
    v_exp_f32 v61, v61
    v_exp_f32 v62, v62
    v_exp_f32 v63, v63
    v_fma_f32 v60, v60, s36, s36
    v_fma_f32 v61, v61, s36, s36
    v_exp_f32 v64, v64
    v_exp_f32 v65, v65
    v_fma_f32 v62, v62, s36, s36
    v_fma_f32 v63, v63, s36, s36
    v_exp_f32 v66, v66
    v_exp_f32 v67, v67
    v_fma_f32 v64, v64, s36, s36
    v_fma_f32 v65, v65, s36, s36
    v_fma_f32 v66, v66, s36, s36
    v_fma_f32 v67, v67, s36, s36
    v_rcp_f32 v60, v60
    v_rcp_f32 v61, v61
    v_rcp_f32 v62, v62
    v_rcp_f32 v63, v63
    v_mul_f32 v60, v44, v60
    v_mul_f32 v61, v45, v61
    v_rcp_f32 v64, v64
    v_rcp_f32 v65, v65
    v_mul_f32 v62, v46, v62
    v_mul_f32 v63, v47, v63
    v_rcp_f32 v66, v66
    v_cvt_pk_bf16_f32 v44, v60, v61
    v_mul_f32 v64, v48, v64
    v_rcp_f32 v67, v67
    v_mul_f32 v65, v49, v65
    v_cvt_pk_bf16_f32 v45, v62, v63
    v_mul_f32 v66, v50, v66
    v_mul_f32 v67, v51, v67
    v_cvt_pk_bf16_f32 v46, v64, v65
    v_cvt_pk_bf16_f32 v47, v66, v67
    v_mul_f32 v68, s37, v68
    v_mul_f32 v69, s37, v69
    v_mul_f32 v70, s37, v70
    v_mul_f32 v71, s37, v71
    v_mul_f32 v72, s37, v72
    v_mul_f32 v73, s37, v73
    v_mul_f32 v74, s37, v74
    v_mul_f32 v75, s37, v75
    v_exp_f32 v68, v68
    v_exp_f32 v69, v69
    v_exp_f32 v70, v70
    v_exp_f32 v71, v71
    v_fma_f32 v68, v68, s36, s36
    v_fma_f32 v69, v69, s36, s36
    s_lshl_b32 s8, s2, 7
    s_lshl_b32 s34, s3, 3
    s_add_u32 s8, s8, s34
    s_add_u32 s8, s8, 524288
    s_add_u32 s35, s33, 32768
    v_add_u32 v117, s35, v6
    v_add_u32 v118, 16384, v117
    s_sub_u32 s18, s35, s39
    s_add_u32 s18, s18, 16384
    s_bfe_u32 s34, s2, 0x40003
    s_lshl_b32 s34, s34, 13
    s_lshl_b32 s35, s3, 11
    s_add_u32 s34, s34, s35
    s_add_u32 s34, s34, 786432
    v_lshl_add_u32 v116, v6, 1, s34
    s_lshl_b32 s35, s39, 1
    s_sub_u32 s11, s34, s35
    v_bfe_u32 v7, v4, 4, 3
    s_mov_b32 s34, 163392
    v_lshl_add_u32 v7, v7, 2, s34
    v_add_u32 v126, 128, v3
    v_cndmask_b32 v124, v126, v3, s[42:43]
    v_cndmask_b32 v125, v126, v3, s[44:45]
    v_cndmask_b32 v126, v126, v3, s[46:47]
    v_subrev_u32 v48, s39, v4
    v_lshrrev_b32 v49, 3, v48
    v_xor_b32 v50, v48, v49
    v_and_b32 v50, 0x70, v50
    v_and_b32 v49, 0x70, v49
    v_lshl_add_u32 v50, v49, 5, v50
    s_lshl_b32 s38, s3, 7
    v_add_u32 v5, s38, v50
    v_lshrrev_b32 v49, 3, v48
    v_and_b32 v49, 32, v49
    v_xor_b32 v48, v48, v49
    v_lshrrev_b32 v49, 4, v48
    v_and_b32 v49, 0x30, v49
    v_xor_b32 v49, v48, v49
    v_and_b32 v49, 0x70, v49
    v_and_b32 v48, 0xf0, v48
    v_lshl_add_u32 v48, v48, 3, v49
    s_add_u32 s35, s41, 16896
    v_add_u32 v127, s35, v48
    s_sub_u32 s9, s35, s39
    s_mul_i32 s10, s3, 28672
    s_add_u32 s10, s10, 734720
    s_setprio 1
    s_barrier
    v_exp_f32 v72, v72
    s_add_u32 m0, s41, 34816
    s_nop 0
    buffer_load_dwordx4 v117, s[4:7], 0 offen offset:0 nt lds
    v_exp_f32 v73, v73
    v_fma_f32 v70, v70, s36, s36
    v_fma_f32 v71, v71, s36, s36
    s_add_u32 m0, s41, 34848
    s_nop 0
    buffer_load_dwordx4 v117, s[4:7], 0 offen offset:1024 nt lds
    v_exp_f32 v74, v74
    v_exp_f32 v75, v75
    v_fma_f32 v72, v72, s36, s36
    v_fma_f32 v73, v73, s36, s36
    s_add_u32 m0, s41, 34880
    s_nop 0
    buffer_load_dwordx4 v117, s[4:7], 0 offen offset:2048 nt lds
    v_fma_f32 v74, v74, s36, s36
    v_fma_f32 v75, v75, s36, s36
    v_rcp_f32 v68, v68
    v_rcp_f32 v69, v69
    s_add_u32 m0, s41, 34912
    s_nop 0
    buffer_load_dwordx4 v117, s[4:7], 0 offen offset:3072 nt lds
    v_rcp_f32 v70, v70
    v_rcp_f32 v71, v71
    v_mul_f32 v68, v52, v68
    v_mul_f32 v69, v53, v69
    v_rcp_f32 v72, v72
    v_rcp_f32 v73, v73
    v_mul_f32 v70, v54, v70
    v_mul_f32 v71, v55, v71
    v_rcp_f32 v74, v74
    v_cvt_pk_bf16_f32 v52, v68, v69
    v_mul_f32 v72, v56, v72
    v_rcp_f32 v75, v75
    v_mul_f32 v73, v57, v73
    v_cvt_pk_bf16_f32 v53, v70, v71
    v_mul_f32 v74, v58, v74
    v_mul_f32 v75, v59, v75
    v_cvt_pk_bf16_f32 v54, v72, v73
    v_cvt_pk_bf16_f32 v55, v74, v75
    s_barrier
    ds_write_b128 v2, v[76:79] offset:0
    ds_write_b128 v2, v[84:87] offset:2304
    ds_write_b128 v2, v[44:47] offset:64
    ds_write_b128 v2, v[52:55] offset:2368
    ds_read_b128 v[48:51], v3 offset:64
    ds_read_b128 v[80:83], v3 offset:2368
    ds_read_b128 v[56:59], v3 offset:80
    ds_read_b128 v[88:91], v3 offset:2384
    ds_read_b128 v[60:63], v3 offset:96
    ds_read_b128 v[72:75], v3 offset:2400
    ds_read_b128 v[64:67], v3 offset:112
    ds_read_b128 v[108:111], v3 offset:2416
    ds_read_b128 v[68:71], v3 offset:128
    ds_read_b128 v[112:115], v3 offset:2432
    s_setprio 3
    s_waitcnt lgkmcnt(9)
    v_mfma_f32_4x4x4_16b_bf16 v[92:95], v[8:9], v[48:49], 0
    s_waitcnt lgkmcnt(8)
    v_mfma_f32_4x4x4_16b_bf16 v[100:103], v[26:27], v[80:81], 0
    v_mfma_f32_4x4x4_16b_bf16 v[92:95], v[10:11], v[50:51], v[92:95]
    s_nop 0
    v_mfma_f32_4x4x4_16b_bf16 v[100:103], v[28:29], v[82:83], v[100:103]
    v_mfma_f32_4x4x4_16b_bf16 v[96:99], v[8:9], v[50:51], 0
    v_mfma_f32_4x4x4_16b_bf16 v[104:107], v[26:27], v[82:83], 0
    s_waitcnt lgkmcnt(7)
    v_mfma_f32_4x4x4_16b_bf16 v[92:95], v[12:13], v[56:57], v[92:95]
    s_waitcnt lgkmcnt(6)
    v_mfma_f32_4x4x4_16b_bf16 v[100:103], v[30:31], v[88:89], v[100:103]
    v_mfma_f32_4x4x4_16b_bf16 v[96:99], v[10:11], v[56:57], v[96:99]
    v_mfma_f32_4x4x4_16b_bf16 v[104:107], v[28:29], v[88:89], v[104:107]
    v_mfma_f32_4x4x4_16b_bf16 v[92:95], v[14:15], v[58:59], v[92:95]
    v_mfma_f32_4x4x4_16b_bf16 v[100:103], v[32:33], v[90:91], v[100:103]
    v_mfma_f32_4x4x4_16b_bf16 v[96:99], v[12:13], v[58:59], v[96:99]
    v_mfma_f32_4x4x4_16b_bf16 v[104:107], v[30:31], v[90:91], v[104:107]
    s_waitcnt lgkmcnt(5)
    v_mfma_f32_4x4x4_16b_bf16 v[92:95], v[16:17], v[60:61], v[92:95]
    s_waitcnt lgkmcnt(4)
    v_mfma_f32_4x4x4_16b_bf16 v[100:103], v[34:35], v[72:73], v[100:103]
    v_mfma_f32_4x4x4_16b_bf16 v[96:99], v[14:15], v[60:61], v[96:99]
    v_mfma_f32_4x4x4_16b_bf16 v[104:107], v[32:33], v[72:73], v[104:107]
    v_mfma_f32_4x4x4_16b_bf16 v[92:95], v[18:19], v[62:63], v[92:95]
    v_mfma_f32_4x4x4_16b_bf16 v[100:103], v[36:37], v[74:75], v[100:103]
    v_mfma_f32_4x4x4_16b_bf16 v[96:99], v[16:17], v[62:63], v[96:99]
    v_mfma_f32_4x4x4_16b_bf16 v[104:107], v[34:35], v[74:75], v[104:107]
    s_waitcnt lgkmcnt(3)
    v_mfma_f32_4x4x4_16b_bf16 v[92:95], v[20:21], v[64:65], v[92:95]
    s_waitcnt lgkmcnt(2)
    v_mfma_f32_4x4x4_16b_bf16 v[100:103], v[38:39], v[108:109], v[100:103]
    v_mfma_f32_4x4x4_16b_bf16 v[96:99], v[18:19], v[64:65], v[96:99]
    v_mfma_f32_4x4x4_16b_bf16 v[104:107], v[36:37], v[108:109], v[104:107]
    v_mfma_f32_4x4x4_16b_bf16 v[92:95], v[22:23], v[66:67], v[92:95]
    v_mfma_f32_4x4x4_16b_bf16 v[100:103], v[40:41], v[110:111], v[100:103]
    v_mfma_f32_4x4x4_16b_bf16 v[96:99], v[20:21], v[66:67], v[96:99]
    v_mfma_f32_4x4x4_16b_bf16 v[104:107], v[38:39], v[110:111], v[104:107]
    s_waitcnt lgkmcnt(1)
    v_mfma_f32_4x4x4_16b_bf16 v[92:95], v[24:25], v[68:69], v[92:95]
    s_waitcnt lgkmcnt(0)
    v_mfma_f32_4x4x4_16b_bf16 v[100:103], v[42:43], v[112:113], v[100:103]
    v_mfma_f32_4x4x4_16b_bf16 v[96:99], v[22:23], v[68:69], v[96:99]
    v_mfma_f32_4x4x4_16b_bf16 v[104:107], v[40:41], v[112:113], v[104:107]
    s_nop 0
    v_mfma_f32_4x4x4_16b_bf16 v[96:99], v[24:25], v[70:71], v[96:99]
    v_mfma_f32_4x4x4_16b_bf16 v[104:107], v[42:43], v[114:115], v[104:107]
    s_setprio 1
    s_load_dwordx4 s[12:15], s[28:29], 0
    v_exp_f32 v76, v92
    s_add_u32 m0, s41, 0
    s_nop 0
    buffer_load_dwordx4 v118, s[4:7], 0 offen offset:0 nt lds
    v_exp_f32 v77, v93
    v_exp_f32 v78, v94
    v_fma_f32 v76, v76, s37, s37
    v_exp_f32 v79, v95
    v_fma_f32 v77, v77, s37, s37
    v_exp_f32 v80, v96
    v_fma_f32 v78, v78, s37, s37
    v_exp_f32 v81, v97
    s_add_u32 m0, s41, 32
    s_nop 0
    buffer_load_dwordx4 v118, s[4:7], 0 offen offset:1024 nt lds
    v_fma_f32 v79, v79, s37, s37
    v_exp_f32 v82, v98
    v_fma_f32 v80, v80, s37, s37
    v_exp_f32 v83, v99
    v_fma_f32 v81, v81, s37, s37
    v_exp_f32 v84, v100
    v_fma_f32 v82, v82, s37, s37
    v_exp_f32 v85, v101
    s_add_u32 m0, s41, 64
    s_nop 0
    buffer_load_dwordx4 v118, s[4:7], 0 offen offset:2048 nt lds
    v_fma_f32 v83, v83, s37, s37
    v_exp_f32 v86, v102
    v_fma_f32 v84, v84, s37, s37
    v_exp_f32 v87, v103
    v_fma_f32 v85, v85, s37, s37
    v_exp_f32 v88, v104
    v_fma_f32 v86, v86, s37, s37
    v_exp_f32 v89, v105
    s_add_u32 m0, s41, 96
    s_nop 0
    buffer_load_dwordx4 v118, s[4:7], 0 offen offset:3072 nt lds
    v_fma_f32 v87, v87, s37, s37
    v_exp_f32 v90, v106
    v_fma_f32 v88, v88, s37, s37
    v_exp_f32 v91, v107
    v_fma_f32 v89, v89, s37, s37
    v_fma_f32 v90, v90, s37, s37
    v_fma_f32 v91, v91, s37, s37
    s_setprio 1
    s_waitcnt lgkmcnt(0)
    s_mov_b32 s34, 0x40000
L_rdyLl:
    s_and_b64 s[12:13], s[12:13], s[14:15]
    s_and_b32 s12, s12, s13
    s_cbranch_scc0 L_rdyLs
L_rdyL:
    s_waitcnt vmcnt(4)
    s_mov_b64 exec, s[0:1]
    ds_write_b32 v7, v7 offset:96
    s_mov_b64 exec, -1
    ds_read_b32 v6, v7 offset:96
    s_waitcnt lgkmcnt(0)
    v_cmp_eq_u32 vcc, 0, v6
    s_and_b32 s34, vcc_lo, 15
    s_cbranch_scc1 L_wL3s
L_wL3:
    ds_read_b128 v[108:111], v0 offset:34816
    ds_read_b128 v[112:115], v0 offset:34848
    ds_read_b128 v[116:119], v0 offset:36928
    ds_read_b128 v[120:123], v0 offset:36960
    s_waitcnt lgkmcnt(2)
    v_mfma_f32_16x16x32_bf16 v[60:63], v[108:111], v[136:139], 0
    v_mfma_f32_16x16x32_bf16 v[60:63], v[112:115], v[152:155], v[60:63]
    v_mfma_f32_16x16x32_bf16 v[68:71], v[108:111], v[140:143], 0
    v_mfma_f32_16x16x32_bf16 v[68:71], v[112:115], v[156:159], v[68:71]
    v_mfma_f32_16x16x32_bf16 v[44:47], v[108:111], v[128:131], 0
    s_setprio 2
    v_mfma_f32_16x16x32_bf16 v[44:47], v[112:115], v[144:147], v[44:47]
    v_mfma_f32_16x16x32_bf16 v[52:55], v[108:111], v[132:135], 0
    ds_read_b128 v[108:111], v0 offset:34944
    v_mfma_f32_16x16x32_bf16 v[52:55], v[112:115], v[148:151], v[52:55]
    ds_read_b128 v[112:115], v0 offset:34976
    s_waitcnt lgkmcnt(2)
    v_mfma_f32_16x16x32_bf16 v[64:67], v[116:119], v[136:139], 0
    v_mfma_f32_16x16x32_bf16 v[64:67], v[120:123], v[152:155], v[64:67]
    v_mfma_f32_16x16x32_bf16 v[72:75], v[116:119], v[140:143], 0
    v_mfma_f32_16x16x32_bf16 v[72:75], v[120:123], v[156:159], v[72:75]
    v_mfma_f32_16x16x32_bf16 v[48:51], v[116:119], v[128:131], 0
    v_mfma_f32_16x16x32_bf16 v[48:51], v[120:123], v[144:147], v[48:51]
    v_mfma_f32_16x16x32_bf16 v[56:59], v[116:119], v[132:135], 0
    ds_read_b128 v[116:119], v0 offset:37056
    v_mfma_f32_16x16x32_bf16 v[56:59], v[120:123], v[148:151], v[56:59]
    ds_read_b128 v[120:123], v0 offset:37088
    s_waitcnt lgkmcnt(2)
    v_mfma_f32_16x16x32_bf16 v[60:63], v[108:111], v[168:171], v[60:63]
    v_mfma_f32_16x16x32_bf16 v[60:63], v[112:115], v[184:187], v[60:63]
    v_mfma_f32_16x16x32_bf16 v[68:71], v[108:111], v[172:175], v[68:71]
    v_mfma_f32_16x16x32_bf16 v[68:71], v[112:115], v[188:191], v[68:71]
    v_mfma_f32_16x16x32_bf16 v[44:47], v[108:111], v[160:163], v[44:47]
    v_mfma_f32_16x16x32_bf16 v[44:47], v[112:115], v[176:179], v[44:47]
    v_mfma_f32_16x16x32_bf16 v[52:55], v[108:111], v[164:167], v[52:55]
    ds_read_b128 v[108:111], v0 offset:35072
    v_mfma_f32_16x16x32_bf16 v[52:55], v[112:115], v[180:183], v[52:55]
    ds_read_b128 v[112:115], v0 offset:35104
    s_waitcnt lgkmcnt(2)
    v_mfma_f32_16x16x32_bf16 v[64:67], v[116:119], v[168:171], v[64:67]
    v_mfma_f32_16x16x32_bf16 v[64:67], v[120:123], v[184:187], v[64:67]
    v_mfma_f32_16x16x32_bf16 v[72:75], v[116:119], v[172:175], v[72:75]
    v_mfma_f32_16x16x32_bf16 v[72:75], v[120:123], v[188:191], v[72:75]
    v_mfma_f32_16x16x32_bf16 v[48:51], v[116:119], v[160:163], v[48:51]
    v_mfma_f32_16x16x32_bf16 v[48:51], v[120:123], v[176:179], v[48:51]
    v_mfma_f32_16x16x32_bf16 v[56:59], v[116:119], v[164:167], v[56:59]
    ds_read_b128 v[116:119], v0 offset:37184
    v_mfma_f32_16x16x32_bf16 v[56:59], v[120:123], v[180:183], v[56:59]
    ds_read_b128 v[120:123], v0 offset:37216
    s_waitcnt lgkmcnt(2)
    v_mfma_f32_16x16x32_bf16 v[60:63], v[108:111], v[200:203], v[60:63]
    v_mfma_f32_16x16x32_bf16 v[60:63], v[112:115], v[216:219], v[60:63]
    v_lshl_add_u32 v6, v4, 1, s11
    s_mov_b32 m0, s48
    s_nop 0
    buffer_load_dword v6, s[24:27], 0 offen sc1 lds
    v_mfma_f32_16x16x32_bf16 v[68:71], v[108:111], v[204:207], v[68:71]
    v_mfma_f32_16x16x32_bf16 v[68:71], v[112:115], v[220:223], v[68:71]
    v_mfma_f32_16x16x32_bf16 v[44:47], v[108:111], v[192:195], v[44:47]
    v_mfma_f32_16x16x32_bf16 v[44:47], v[112:115], v[208:211], v[44:47]
    v_mfma_f32_16x16x32_bf16 v[52:55], v[108:111], v[196:199], v[52:55]
    ds_read_b128 v[108:111], v0 offset:35200
    v_mfma_f32_16x16x32_bf16 v[52:55], v[112:115], v[212:215], v[52:55]
    ds_read_b128 v[112:115], v0 offset:35232
    s_waitcnt lgkmcnt(2)
    v_mfma_f32_16x16x32_bf16 v[64:67], v[116:119], v[200:203], v[64:67]
    v_mfma_f32_16x16x32_bf16 v[64:67], v[120:123], v[216:219], v[64:67]
    v_mfma_f32_16x16x32_bf16 v[72:75], v[116:119], v[204:207], v[72:75]
    v_mfma_f32_16x16x32_bf16 v[72:75], v[120:123], v[220:223], v[72:75]
    v_mfma_f32_16x16x32_bf16 v[48:51], v[116:119], v[192:195], v[48:51]
    v_mfma_f32_16x16x32_bf16 v[48:51], v[120:123], v[208:211], v[48:51]
    v_mfma_f32_16x16x32_bf16 v[56:59], v[116:119], v[196:199], v[56:59]
    ds_read_b128 v[116:119], v0 offset:37312
    v_mfma_f32_16x16x32_bf16 v[56:59], v[120:123], v[212:215], v[56:59]
    ds_read_b128 v[120:123], v0 offset:37344
    s_waitcnt lgkmcnt(2)
    v_mfma_f32_16x16x32_bf16 v[60:63], v[108:111], v[232:235], v[60:63]
    v_mfma_f32_16x16x32_bf16 v[60:63], v[112:115], v[248:251], v[60:63]
    v_mfma_f32_16x16x32_bf16 v[68:71], v[108:111], v[236:239], v[68:71]
    v_mfma_f32_16x16x32_bf16 v[68:71], v[112:115], v[252:255], v[68:71]
    v_mfma_f32_16x16x32_bf16 v[44:47], v[108:111], v[224:227], v[44:47]
    v_mfma_f32_16x16x32_bf16 v[44:47], v[112:115], v[240:243], v[44:47]
    v_mfma_f32_16x16x32_bf16 v[52:55], v[108:111], v[228:231], v[52:55]
    v_mfma_f32_16x16x32_bf16 v[52:55], v[112:115], v[244:247], v[52:55]
    ds_read_b128 v[108:111], v2 offset:0
    ds_read_b128 v[112:115], v2 offset:2304
    s_waitcnt lgkmcnt(2)
    v_mfma_f32_16x16x32_bf16 v[64:67], v[116:119], v[232:235], v[64:67]
    v_mfma_f32_16x16x32_bf16 v[64:67], v[120:123], v[248:251], v[64:67]
    v_mfma_f32_16x16x32_bf16 v[72:75], v[116:119], v[236:239], v[72:75]
    v_mfma_f32_16x16x32_bf16 v[72:75], v[120:123], v[252:255], v[72:75]
    v_mfma_f32_16x16x32_bf16 v[48:51], v[116:119], v[224:227], v[48:51]
    v_mfma_f32_16x16x32_bf16 v[48:51], v[120:123], v[240:243], v[48:51]
    s_waitcnt lgkmcnt(1)
    buffer_store_dwordx4 v[108:111], v4, s[24:27], s49 offen offset:0 sc1
    v_mfma_f32_16x16x32_bf16 v[56:59], v[116:119], v[228:231], v[56:59]
    v_mfma_f32_16x16x32_bf16 v[56:59], v[120:123], v[244:247], v[56:59]
    s_waitcnt lgkmcnt(0)
    buffer_store_dwordx4 v[112:115], v4, s[24:27], s49 offen offset:1024 sc1
    s_setprio 0
    v_rcp_f32 v76, v76
    v_rcp_f32 v77, v77
    v_rcp_f32 v78, v78
    v_rcp_f32 v79, v79
    v_mul_f32 v76, v92, v76
    v_mul_f32 v77, v93, v77
    v_rcp_f32 v80, v80
    v_rcp_f32 v81, v81
    v_mul_f32 v78, v94, v78
    v_mul_f32 v79, v95, v79
    v_rcp_f32 v82, v82
    v_cvt_pk_bf16_f32 v92, v76, v77
    v_mul_f32 v80, v96, v80
    v_rcp_f32 v83, v83
    v_mul_f32 v81, v97, v81
    v_cvt_pk_bf16_f32 v93, v78, v79
    v_rcp_f32 v84, v84
    v_rcp_f32 v85, v85
    v_mul_f32 v82, v98, v82
    v_mul_f32 v83, v99, v83
    v_rcp_f32 v86, v86
    v_cvt_pk_bf16_f32 v94, v80, v81
    v_mul_f32 v84, v100, v84
    v_rcp_f32 v87, v87
    v_mul_f32 v85, v101, v85
    v_cvt_pk_bf16_f32 v95, v82, v83
    v_rcp_f32 v88, v88
    v_rcp_f32 v89, v89
    v_mul_f32 v86, v102, v86
    v_mul_f32 v87, v103, v87
    v_rcp_f32 v90, v90
    v_cvt_pk_bf16_f32 v100, v84, v85
    v_mul_f32 v88, v104, v88
    v_rcp_f32 v91, v91
    v_mul_f32 v89, v105, v89
    v_cvt_pk_bf16_f32 v101, v86, v87
    v_mul_f32 v90, v106, v90
    v_mul_f32 v91, v107, v91
    v_cvt_pk_bf16_f32 v102, v88, v89
    v_cvt_pk_bf16_f32 v103, v90, v91
    v_mul_f32 v60, s37, v60
    v_mul_f32 v61, s37, v61
    v_mul_f32 v62, s37, v62
    v_mul_f32 v63, s37, v63
    v_mul_f32 v64, s37, v64
    v_mul_f32 v65, s37, v65
    v_mul_f32 v66, s37, v66
    v_mul_f32 v67, s37, v67
    v_mul_f32 v68, s37, v68
    v_mul_f32 v69, s37, v69
    v_mul_f32 v70, s37, v70
    v_mul_f32 v71, s37, v71
    v_mul_f32 v72, s37, v72
    v_mul_f32 v73, s37, v73
    v_mul_f32 v74, s37, v74
    v_mul_f32 v75, s37, v75
    v_exp_f32 v60, v60
    v_exp_f32 v61, v61
    v_exp_f32 v62, v62
    v_exp_f32 v63, v63
    v_fma_f32 v60, v60, s36, s36
    v_fma_f32 v61, v61, s36, s36
    v_exp_f32 v64, v64
    v_exp_f32 v65, v65
    v_fma_f32 v62, v62, s36, s36
    v_fma_f32 v63, v63, s36, s36
    v_exp_f32 v66, v66
    v_exp_f32 v67, v67
    v_fma_f32 v64, v64, s36, s36
    v_fma_f32 v65, v65, s36, s36
    v_exp_f32 v68, v68
    v_exp_f32 v69, v69
    v_fma_f32 v66, v66, s36, s36
    v_fma_f32 v67, v67, s36, s36
    v_exp_f32 v70, v70
    v_exp_f32 v71, v71
    v_fma_f32 v68, v68, s36, s36
    v_fma_f32 v69, v69, s36, s36
    v_exp_f32 v72, v72
    v_exp_f32 v73, v73
    v_fma_f32 v70, v70, s36, s36
    s_setprio 0
    s_waitcnt vmcnt(3)
    s_mov_b64 exec, s[0:1]
    ds_write_b32 v7, v7 offset:128
    s_mov_b64 exec, -1
    v_fma_f32 v71, v71, s36, s36
    v_exp_f32 v74, v74
    v_exp_f32 v75, v75
    v_fma_f32 v72, v72, s36, s36
    v_fma_f32 v73, v73, s36, s36
    v_fma_f32 v74, v74, s36, s36
    v_fma_f32 v75, v75, s36, s36
    v_rcp_f32 v60, v60
    v_rcp_f32 v61, v61
    v_rcp_f32 v62, v62
    v_rcp_f32 v63, v63
    v_mul_f32 v60, v44, v60
    v_mul_f32 v61, v45, v61
    v_rcp_f32 v64, v64
    ds_read_b32 v6, v7 offset:128
    v_rcp_f32 v65, v65
    v_mul_f32 v62, v46, v62
    v_mul_f32 v63, v47, v63
    v_rcp_f32 v66, v66
    v_cvt_pk_bf16_f32 v76, v60, v61
    v_mul_f32 v64, v48, v64
    v_rcp_f32 v67, v67
    v_mul_f32 v65, v49, v65
    v_cvt_pk_bf16_f32 v77, v62, v63
    v_rcp_f32 v68, v68
    v_rcp_f32 v69, v69
    v_mul_f32 v66, v50, v66
    v_mul_f32 v67, v51, v67
    v_rcp_f32 v70, v70
    s_waitcnt lgkmcnt(0)
    v_cmp_eq_u32 vcc, 0, v6
    s_and_b32 s34, vcc_lo, 15
    s_cbranch_scc1 L_wL4s
L_wL4:
    ds_read_b128 v[108:111], v0 offset:0
    ds_read_b128 v[112:115], v0 offset:32
    ds_read_b128 v[116:119], v0 offset:2112
    ds_read_b128 v[120:123], v0 offset:2144
    v_cvt_pk_bf16_f32 v78, v64, v65
    v_mul_f32 v68, v52, v68
    v_rcp_f32 v71, v71
    v_mul_f32 v69, v53, v69
    v_cvt_pk_bf16_f32 v79, v66, v67
    v_rcp_f32 v72, v72
    v_rcp_f32 v73, v73
    v_mul_f32 v70, v54, v70
    v_mul_f32 v71, v55, v71
    v_rcp_f32 v74, v74
    v_cvt_pk_bf16_f32 v80, v68, v69
    v_mul_f32 v72, v56, v72
    v_rcp_f32 v75, v75
    v_mul_f32 v73, v57, v73
    v_cvt_pk_bf16_f32 v81, v70, v71
    v_mul_f32 v74, v58, v74
    v_mul_f32 v75, v59, v75
    v_cvt_pk_bf16_f32 v82, v72, v73
    v_cvt_pk_bf16_f32 v83, v74, v75
    s_setprio 1
    s_waitcnt lgkmcnt(2)
    v_mfma_f32_16x16x32_bf16 v[60:63], v[108:111], v[136:139], 0
    v_mfma_f32_16x16x32_bf16 v[60:63], v[112:115], v[152:155], v[60:63]
    ds_write_b128 v2, v[76:79] offset:0
    v_mfma_f32_16x16x32_bf16 v[68:71], v[108:111], v[140:143], 0
    v_mfma_f32_16x16x32_bf16 v[68:71], v[112:115], v[156:159], v[68:71]
    v_mfma_f32_16x16x32_bf16 v[44:47], v[108:111], v[128:131], 0
    s_setprio 2
    v_mfma_f32_16x16x32_bf16 v[44:47], v[112:115], v[144:147], v[44:47]
    v_mfma_f32_16x16x32_bf16 v[52:55], v[108:111], v[132:135], 0
    ds_read_b128 v[108:111], v0 offset:128
    v_mfma_f32_16x16x32_bf16 v[52:55], v[112:115], v[148:151], v[52:55]
    ds_read_b128 v[112:115], v0 offset:160
    s_waitcnt lgkmcnt(3)
    v_mfma_f32_16x16x32_bf16 v[64:67], v[116:119], v[136:139], 0
    v_mfma_f32_16x16x32_bf16 v[64:67], v[120:123], v[152:155], v[64:67]
    ds_write_b128 v2, v[80:83] offset:2304
    v_mfma_f32_16x16x32_bf16 v[72:75], v[116:119], v[140:143], 0
    v_mfma_f32_16x16x32_bf16 v[72:75], v[120:123], v[156:159], v[72:75]
    s_waitcnt vmcnt(0)
    s_mov_b64 exec, s[0:1]
    buffer_store_dword v7, off, s[24:27], s8 sc1
    s_mov_b64 exec, -1
    v_mfma_f32_16x16x32_bf16 v[48:51], v[116:119], v[128:131], 0
    v_mfma_f32_16x16x32_bf16 v[48:51], v[120:123], v[144:147], v[48:51]
    v_mfma_f32_16x16x32_bf16 v[56:59], v[116:119], v[132:135], 0
    ds_read_b128 v[116:119], v0 offset:2240
    v_mfma_f32_16x16x32_bf16 v[56:59], v[120:123], v[148:151], v[56:59]
    ds_read_b128 v[120:123], v0 offset:2272
    s_waitcnt lgkmcnt(3)
    v_mfma_f32_16x16x32_bf16 v[60:63], v[108:111], v[168:171], v[60:63]
    buffer_load_dwordx4 v[128:131], v4, s[24:27], s10 offen offset:0 sc1
    v_mfma_f32_16x16x32_bf16 v[60:63], v[112:115], v[184:187], v[60:63]
    ds_write_b128 v4, v[92:95] offset:0
    v_mfma_f32_16x16x32_bf16 v[68:71], v[108:111], v[172:175], v[68:71]
    v_mfma_f32_16x16x32_bf16 v[68:71], v[112:115], v[188:191], v[68:71]
    buffer_load_dwordx4 v[132:135], v4, s[24:27], s10 offen offset:1024 sc1
    v_mfma_f32_16x16x32_bf16 v[44:47], v[108:111], v[160:163], v[44:47]
    v_mfma_f32_16x16x32_bf16 v[44:47], v[112:115], v[176:179], v[44:47]
    buffer_load_dwordx4 v[136:139], v4, s[24:27], s10 offen offset:2048 sc1
    v_mfma_f32_16x16x32_bf16 v[52:55], v[108:111], v[164:167], v[52:55]
    ds_read_b128 v[108:111], v0 offset:256
    v_mfma_f32_16x16x32_bf16 v[52:55], v[112:115], v[180:183], v[52:55]
    ds_read_b128 v[112:115], v0 offset:288
    s_waitcnt lgkmcnt(3)
    v_mfma_f32_16x16x32_bf16 v[64:67], v[116:119], v[168:171], v[64:67]
    v_mfma_f32_16x16x32_bf16 v[64:67], v[120:123], v[184:187], v[64:67]
    ds_write_b128 v4, v[100:103] offset:1024
    v_mfma_f32_16x16x32_bf16 v[72:75], v[116:119], v[172:175], v[72:75]
    v_mfma_f32_16x16x32_bf16 v[72:75], v[120:123], v[188:191], v[72:75]
    s_mov_b64 exec, s[0:1]
    ds_write_b32 v7, v7 offset:64
    s_mov_b64 exec, -1
    v_mfma_f32_16x16x32_bf16 v[48:51], v[116:119], v[160:163], v[48:51]
    buffer_load_dwordx4 v[140:143], v4, s[24:27], s10 offen offset:3072 sc1
    s_add_u32 s10, s10, 4096
    v_mfma_f32_16x16x32_bf16 v[48:51], v[120:123], v[176:179], v[48:51]
    buffer_load_dwordx4 v[144:147], v4, s[24:27], s10 offen offset:0 sc1
    v_mfma_f32_16x16x32_bf16 v[56:59], v[116:119], v[164:167], v[56:59]
    ds_read_b128 v[116:119], v0 offset:2368
    v_mfma_f32_16x16x32_bf16 v[56:59], v[120:123], v[180:183], v[56:59]
    ds_read_b128 v[120:123], v0 offset:2400
    s_waitcnt lgkmcnt(4)
    v_mfma_f32_16x16x32_bf16 v[60:63], v[108:111], v[200:203], v[60:63]
    v_mfma_f32_16x16x32_bf16 v[60:63], v[112:115], v[216:219], v[60:63]
    buffer_load_dwordx4 v[148:151], v4, s[24:27], s10 offen offset:1024 sc1
    v_mfma_f32_16x16x32_bf16 v[68:71], v[108:111], v[204:207], v[68:71]
    v_mfma_f32_16x16x32_bf16 v[68:71], v[112:115], v[220:223], v[68:71]
    s_cmp_eq_u32 s50, 125
    s_cbranch_scc1 L_end
    v_mfma_f32_16x16x32_bf16 v[44:47], v[108:111], v[192:195], v[44:47]
    v_mfma_f32_16x16x32_bf16 v[44:47], v[112:115], v[208:211], v[44:47]
    buffer_load_dwordx4 v[152:155], v4, s[24:27], s10 offen offset:2048 sc1
    v_mfma_f32_16x16x32_bf16 v[52:55], v[108:111], v[196:199], v[52:55]
    ds_read_b128 v[108:111], v0 offset:384
    v_mfma_f32_16x16x32_bf16 v[52:55], v[112:115], v[212:215], v[52:55]
    ds_read_b128 v[112:115], v0 offset:416
    s_waitcnt lgkmcnt(2)
    v_mfma_f32_16x16x32_bf16 v[64:67], v[116:119], v[200:203], v[64:67]
    v_mfma_f32_16x16x32_bf16 v[64:67], v[120:123], v[216:219], v[64:67]
    buffer_load_dwordx4 v[156:159], v4, s[24:27], s10 offen offset:3072 sc1
    s_add_u32 s10, s10, 4096
    v_mfma_f32_16x16x32_bf16 v[72:75], v[116:119], v[204:207], v[72:75]
    v_mfma_f32_16x16x32_bf16 v[72:75], v[120:123], v[220:223], v[72:75]
    v_mfma_f32_16x16x32_bf16 v[48:51], v[116:119], v[192:195], v[48:51]
    v_mfma_f32_16x16x32_bf16 v[48:51], v[120:123], v[208:211], v[48:51]
    buffer_load_dwordx4 v[160:163], v4, s[24:27], s10 offen offset:0 sc1
    v_mfma_f32_16x16x32_bf16 v[56:59], v[116:119], v[196:199], v[56:59]
    ds_read_b128 v[116:119], v0 offset:2496
    v_mfma_f32_16x16x32_bf16 v[56:59], v[120:123], v[212:215], v[56:59]
    ds_read_b128 v[120:123], v0 offset:2528
    s_waitcnt lgkmcnt(2)
    v_mfma_f32_16x16x32_bf16 v[60:63], v[108:111], v[232:235], v[60:63]
    v_mfma_f32_16x16x32_bf16 v[60:63], v[112:115], v[248:251], v[60:63]
    buffer_load_dwordx4 v[164:167], v4, s[24:27], s10 offen offset:1024 sc1
    v_mfma_f32_16x16x32_bf16 v[68:71], v[108:111], v[236:239], v[68:71]
    ds_read_b128 v[76:79], v3 offset:128
    ds_read_b128 v[84:87], v3 offset:2432
    v_mfma_f32_16x16x32_bf16 v[68:71], v[112:115], v[252:255], v[68:71]
    ds_read_b128 v[80:83], v124 offset:16
    ds_read_b128 v[88:91], v124 offset:2320
    v_mfma_f32_16x16x32_bf16 v[44:47], v[108:111], v[224:227], v[44:47]
    v_mfma_f32_16x16x32_bf16 v[44:47], v[112:115], v[240:243], v[44:47]
    buffer_load_dwordx4 v[168:171], v4, s[24:27], s10 offen offset:2048 sc1
    v_mfma_f32_16x16x32_bf16 v[52:55], v[108:111], v[228:231], v[52:55]
    ds_read_b128 v[200:203], v125 offset:32
    ds_read_b128 v[204:207], v125 offset:2336
    v_mfma_f32_16x16x32_bf16 v[52:55], v[112:115], v[244:247], v[52:55]
    ds_read_b128 v[208:211], v126 offset:48
    ds_read_b128 v[212:215], v126 offset:2352
    s_waitcnt lgkmcnt(8)
    v_mfma_f32_16x16x32_bf16 v[64:67], v[116:119], v[232:235], v[64:67]
    v_mfma_f32_16x16x32_bf16 v[64:67], v[120:123], v[248:251], v[64:67]
    buffer_load_dwordx4 v[172:175], v4, s[24:27], s10 offen offset:3072 sc1
    s_add_u32 s10, s10, 4096
    v_mfma_f32_16x16x32_bf16 v[72:75], v[116:119], v[236:239], v[72:75]
    ds_read_b128 v[216:219], v3 offset:64
    ds_read_b128 v[220:223], v3 offset:2368
    v_mfma_f32_16x16x32_bf16 v[72:75], v[120:123], v[252:255], v[72:75]
    v_xor_b32 v0, 32, v1
    v_mfma_f32_16x16x32_bf16 v[48:51], v[116:119], v[224:227], v[48:51]
    v_mfma_f32_16x16x32_bf16 v[48:51], v[120:123], v[240:243], v[48:51]
    buffer_load_dwordx4 v[176:179], v4, s[24:27], s10 offen offset:0 sc1
    v_mfma_f32_16x16x32_bf16 v[56:59], v[116:119], v[228:231], v[56:59]
    v_mfma_f32_16x16x32_bf16 v[56:59], v[120:123], v[244:247], v[56:59]
    buffer_load_dwordx4 v[180:183], v4, s[24:27], s10 offen offset:1024 sc1
    s_setprio 3
    s_waitcnt lgkmcnt(0)
    v_mfma_f32_4x4x4_16b_bf16 v[92:95], v[8:9], v[76:77], 0
    v_mul_f32 v60, s37, v60
    v_mfma_f32_4x4x4_16b_bf16 v[100:103], v[26:27], v[84:85], 0
    v_mul_f32 v61, s37, v61
    v_mfma_f32_4x4x4_16b_bf16 v[92:95], v[10:11], v[78:79], v[92:95]
    v_mul_f32 v62, s37, v62
    v_mfma_f32_4x4x4_16b_bf16 v[100:103], v[28:29], v[86:87], v[100:103]
    v_mul_f32 v63, s37, v63
    v_mfma_f32_4x4x4_16b_bf16 v[96:99], v[8:9], v[78:79], 0
    v_mul_f32 v64, s37, v64
    v_mfma_f32_4x4x4_16b_bf16 v[104:107], v[26:27], v[86:87], 0
    v_mul_f32 v65, s37, v65
    v_mfma_f32_4x4x4_16b_bf16 v[92:95], v[12:13], v[80:81], v[92:95]
    v_mul_f32 v66, s37, v66
    v_mfma_f32_4x4x4_16b_bf16 v[100:103], v[30:31], v[88:89], v[100:103]
    v_mul_f32 v67, s37, v67
    v_mfma_f32_4x4x4_16b_bf16 v[96:99], v[10:11], v[80:81], v[96:99]
    v_mul_f32 v68, s37, v68
    v_mfma_f32_4x4x4_16b_bf16 v[104:107], v[28:29], v[88:89], v[104:107]
    v_mul_f32 v69, s37, v69
    v_mfma_f32_4x4x4_16b_bf16 v[92:95], v[14:15], v[82:83], v[92:95]
    v_mul_f32 v70, s37, v70
    v_mfma_f32_4x4x4_16b_bf16 v[100:103], v[32:33], v[90:91], v[100:103]
    v_mul_f32 v71, s37, v71
    v_mfma_f32_4x4x4_16b_bf16 v[96:99], v[12:13], v[82:83], v[96:99]
    v_mul_f32 v72, s37, v72
    v_mfma_f32_4x4x4_16b_bf16 v[104:107], v[30:31], v[90:91], v[104:107]
    v_mul_f32 v73, s37, v73
    v_mfma_f32_4x4x4_16b_bf16 v[92:95], v[16:17], v[200:201], v[92:95]
    v_mul_f32 v74, s37, v74
    v_mfma_f32_4x4x4_16b_bf16 v[100:103], v[34:35], v[204:205], v[100:103]
    v_mul_f32 v75, s37, v75
    s_setprio 0
    v_exp_f32 v60, v60
    v_exp_f32 v61, v61
    v_exp_f32 v62, v62
    v_exp_f32 v63, v63
    v_fma_f32 v60, v60, s36, s36
    buffer_load_dwordx4 v[184:187], v4, s[24:27], s10 offen offset:2048 sc1
    v_fma_f32 v61, v61, s36, s36
    v_exp_f32 v64, v64
    v_exp_f32 v65, v65
    v_fma_f32 v62, v62, s36, s36
    v_fma_f32 v63, v63, s36, s36
    v_exp_f32 v66, v66
    v_exp_f32 v67, v67
    v_fma_f32 v64, v64, s36, s36
    v_fma_f32 v65, v65, s36, s36
    v_exp_f32 v68, v68
    buffer_load_dwordx4 v[188:191], v4, s[24:27], s10 offen offset:3072 sc1
    s_add_u32 s10, s10, 4096
    v_exp_f32 v69, v69
    v_fma_f32 v66, v66, s36, s36
    v_fma_f32 v67, v67, s36, s36
    v_exp_f32 v70, v70
    v_exp_f32 v71, v71
    v_fma_f32 v68, v68, s36, s36
    v_fma_f32 v69, v69, s36, s36
    v_exp_f32 v72, v72
    v_exp_f32 v73, v73
    v_fma_f32 v70, v70, s36, s36
    buffer_load_dwordx4 v[192:195], v4, s[24:27], s10 offen offset:0 sc1
    v_fma_f32 v71, v71, s36, s36
    v_exp_f32 v74, v74
    v_exp_f32 v75, v75
    v_fma_f32 v72, v72, s36, s36
    v_fma_f32 v73, v73, s36, s36
    v_fma_f32 v74, v74, s36, s36
    v_fma_f32 v75, v75, s36, s36
    v_rcp_f32 v60, v60
    v_rcp_f32 v61, v61
    v_rcp_f32 v62, v62
    buffer_load_dwordx4 v[196:199], v4, s[24:27], s10 offen offset:1024 sc1
    v_rcp_f32 v63, v63
    v_rcp_f32 v64, v64
    v_rcp_f32 v65, v65
    v_rcp_f32 v66, v66
    v_rcp_f32 v67, v67
    v_rcp_f32 v68, v68
    v_rcp_f32 v69, v69
    v_rcp_f32 v70, v70
    v_rcp_f32 v71, v71
    v_rcp_f32 v72, v72
    v_rcp_f32 v73, v73
    v_rcp_f32 v74, v74
    v_rcp_f32 v75, v75
    s_setprio 3
    v_mfma_f32_4x4x4_16b_bf16 v[96:99], v[14:15], v[200:201], v[96:99]
    v_mul_f32 v60, v44, v60
    v_mfma_f32_4x4x4_16b_bf16 v[104:107], v[32:33], v[204:205], v[104:107]
    v_mul_f32 v61, v45, v61
    v_mfma_f32_4x4x4_16b_bf16 v[92:95], v[18:19], v[202:203], v[92:95]
    v_mul_f32 v62, v46, v62
    v_mfma_f32_4x4x4_16b_bf16 v[100:103], v[36:37], v[206:207], v[100:103]
    v_mul_f32 v63, v47, v63
    v_mfma_f32_4x4x4_16b_bf16 v[96:99], v[16:17], v[202:203], v[96:99]
    v_mul_f32 v64, v48, v64
    v_mfma_f32_4x4x4_16b_bf16 v[104:107], v[34:35], v[206:207], v[104:107]
    v_mul_f32 v65, v49, v65
    v_mfma_f32_4x4x4_16b_bf16 v[92:95], v[20:21], v[208:209], v[92:95]
    v_cvt_pk_bf16_f32 v44, v60, v61
    v_mfma_f32_4x4x4_16b_bf16 v[100:103], v[38:39], v[212:213], v[100:103]
    v_mul_f32 v66, v50, v66
    v_mfma_f32_4x4x4_16b_bf16 v[96:99], v[18:19], v[208:209], v[96:99]
    v_mul_f32 v67, v51, v67
    v_mfma_f32_4x4x4_16b_bf16 v[104:107], v[36:37], v[212:213], v[104:107]
    v_mul_f32 v68, v52, v68
    v_mfma_f32_4x4x4_16b_bf16 v[92:95], v[22:23], v[210:211], v[92:95]
    v_mul_f32 v69, v53, v69
    v_mfma_f32_4x4x4_16b_bf16 v[100:103], v[40:41], v[214:215], v[100:103]
    v_mul_f32 v70, v54, v70
    v_mfma_f32_4x4x4_16b_bf16 v[96:99], v[20:21], v[210:211], v[96:99]
    v_mul_f32 v71, v55, v71
    v_mfma_f32_4x4x4_16b_bf16 v[104:107], v[38:39], v[214:215], v[104:107]
    v_cvt_pk_bf16_f32 v45, v62, v63
    v_mfma_f32_4x4x4_16b_bf16 v[92:95], v[24:25], v[216:217], v[92:95]
    v_mul_f32 v72, v56, v72
    v_mfma_f32_4x4x4_16b_bf16 v[100:103], v[42:43], v[220:221], v[100:103]
    v_mul_f32 v73, v57, v73
    v_mfma_f32_4x4x4_16b_bf16 v[96:99], v[22:23], v[216:217], v[96:99]
    v_mul_f32 v74, v58, v74
    v_mfma_f32_4x4x4_16b_bf16 v[104:107], v[40:41], v[220:221], v[104:107]
    v_mul_f32 v75, v59, v75
    v_mfma_f32_4x4x4_16b_bf16 v[96:99], v[24:25], v[218:219], v[96:99]
    v_mfma_f32_4x4x4_16b_bf16 v[104:107], v[42:43], v[222:223], v[104:107]
    s_setprio 0
    v_cvt_pk_bf16_f32 v46, v64, v65
    v_cvt_pk_bf16_f32 v47, v66, v67
    v_cvt_pk_bf16_f32 v48, v68, v69
    v_cvt_pk_bf16_f32 v49, v70, v71
    v_cvt_pk_bf16_f32 v50, v72, v73
    v_cvt_pk_bf16_f32 v51, v74, v75
    ds_write_b128 v2, v[44:47] offset:64
    ds_write_b128 v2, v[48:51] offset:2368
    v_exp_f32 v76, v92
    v_exp_f32 v77, v93
    v_exp_f32 v78, v94
    buffer_load_dwordx4 v[200:203], v4, s[24:27], s10 offen offset:2048 sc1
    v_exp_f32 v79, v95
    v_fma_f32 v76, v76, s37, s37
    v_fma_f32 v77, v77, s37, s37
    v_exp_f32 v80, v96
    v_exp_f32 v81, v97
    v_fma_f32 v78, v78, s37, s37
    v_fma_f32 v79, v79, s37, s37
    v_exp_f32 v82, v98
    v_exp_f32 v83, v99
    v_fma_f32 v80, v80, s37, s37
    v_fma_f32 v81, v81, s37, s37
    buffer_load_dwordx4 v[204:207], v4, s[24:27], s10 offen offset:3072 sc1
    s_add_u32 s10, s10, 4096
    v_exp_f32 v84, v100
    v_exp_f32 v85, v101
    v_fma_f32 v82, v82, s37, s37
    v_fma_f32 v83, v83, s37, s37
    v_exp_f32 v86, v102
    v_exp_f32 v87, v103
    v_fma_f32 v84, v84, s37, s37
    ds_read_b128 v[216:219], v3 offset:64
    ds_read_b128 v[236:239], v3 offset:2368
    ds_read_b128 v[220:223], v3 offset:80
    ds_read_b128 v[240:243], v3 offset:2384
    ds_read_b128 v[224:227], v3 offset:96
    ds_read_b32 v6, v7 offset:64
    v_fma_f32 v85, v85, s37, s37
    v_exp_f32 v88, v104
    v_exp_f32 v89, v105
    buffer_load_dwordx4 v[208:211], v4, s[24:27], s10 offen offset:0 sc1
    v_fma_f32 v86, v86, s37, s37
    v_fma_f32 v87, v87, s37, s37
    v_exp_f32 v90, v106
    v_exp_f32 v91, v107
    v_fma_f32 v88, v88, s37, s37
    v_fma_f32 v89, v89, s37, s37
    v_fma_f32 v90, v90, s37, s37
    ds_read_b128 v[244:247], v3 offset:2400
    ds_read_b128 v[228:231], v3 offset:112
    ds_read_b128 v[248:251], v3 offset:2416
    ds_read_b128 v[232:235], v3 offset:128
    ds_read_b128 v[252:255], v3 offset:2432
    v_fma_f32 v91, v91, s37, s37
    v_rcp_f32 v76, v76
    v_rcp_f32 v77, v77
    buffer_load_dwordx4 v[212:215], v4, s[24:27], s10 offen offset:1024 sc1
    v_rcp_f32 v78, v78
    v_rcp_f32 v79, v79
    v_rcp_f32 v80, v80
    v_rcp_f32 v81, v81
    v_rcp_f32 v82, v82
    v_rcp_f32 v83, v83
    v_rcp_f32 v84, v84
    v_rcp_f32 v85, v85
    v_rcp_f32 v86, v86
    v_rcp_f32 v87, v87
    v_rcp_f32 v88, v88
    v_rcp_f32 v89, v89
    v_rcp_f32 v90, v90
    v_rcp_f32 v91, v91
    s_setprio 3
    s_waitcnt lgkmcnt(0)
    v_cmp_eq_u32 vcc, 0, v6
    s_and_b32 s34, vcc_lo, 255
    s_cbranch_scc1 L_wL2s
L_wL2:
    ds_read_b64_tr_b16 v[108:109], v1 offset:0
    ds_read_b64_tr_b16 v[110:111], v1 offset:1024
    ds_read_b64_tr_b16 v[112:113], v1 offset:2048
    ds_read_b64_tr_b16 v[114:115], v1 offset:3072
    ds_read_b64_tr_b16 v[116:117], v0 offset:0
    ds_read_b64_tr_b16 v[118:119], v0 offset:1024
    ds_read_b64_tr_b16 v[120:121], v0 offset:2048
    ds_read_b64_tr_b16 v[122:123], v0 offset:3072
    v_mfma_f32_4x4x4_16b_bf16 v[60:63], v[8:9], v[216:217], 0
    v_mul_f32 v76, v92, v76
    v_mfma_f32_4x4x4_16b_bf16 v[68:71], v[26:27], v[236:237], 0
    v_mul_f32 v77, v93, v77
    v_mfma_f32_4x4x4_16b_bf16 v[60:63], v[10:11], v[218:219], v[60:63]
    v_mfma_f32_4x4x4_16b_bf16 v[68:71], v[28:29], v[238:239], v[68:71]
    v_mul_f32 v78, v94, v78
    v_mfma_f32_4x4x4_16b_bf16 v[64:67], v[8:9], v[218:219], 0
    v_mul_f32 v79, v95, v79
    v_mfma_f32_4x4x4_16b_bf16 v[72:75], v[26:27], v[238:239], 0
    v_mfma_f32_4x4x4_16b_bf16 v[60:63], v[12:13], v[220:221], v[60:63]
    v_cvt_pk_bf16_f32 v92, v76, v77
    v_mfma_f32_4x4x4_16b_bf16 v[68:71], v[30:31], v[240:241], v[68:71]
    v_mul_f32 v80, v96, v80
    v_mfma_f32_4x4x4_16b_bf16 v[64:67], v[10:11], v[220:221], v[64:67]
    v_mfma_f32_4x4x4_16b_bf16 v[72:75], v[28:29], v[240:241], v[72:75]
    v_mul_f32 v81, v97, v81
    v_mfma_f32_4x4x4_16b_bf16 v[60:63], v[14:15], v[222:223], v[60:63]
    v_cvt_pk_bf16_f32 v93, v78, v79
    v_mfma_f32_4x4x4_16b_bf16 v[68:71], v[32:33], v[242:243], v[68:71]
    v_mfma_f32_4x4x4_16b_bf16 v[64:67], v[12:13], v[222:223], v[64:67]
    v_mul_f32 v82, v98, v82
    v_mfma_f32_4x4x4_16b_bf16 v[72:75], v[30:31], v[242:243], v[72:75]
    v_mul_f32 v83, v99, v83
    v_mfma_f32_4x4x4_16b_bf16 v[60:63], v[16:17], v[224:225], v[60:63]
    v_mfma_f32_4x4x4_16b_bf16 v[68:71], v[34:35], v[244:245], v[68:71]
    v_cvt_pk_bf16_f32 v94, v80, v81
    v_mfma_f32_4x4x4_16b_bf16 v[64:67], v[14:15], v[224:225], v[64:67]
    v_mul_f32 v84, v100, v84
    v_mfma_f32_4x4x4_16b_bf16 v[72:75], v[32:33], v[244:245], v[72:75]
    v_mfma_f32_4x4x4_16b_bf16 v[60:63], v[18:19], v[226:227], v[60:63]
    v_mul_f32 v85, v101, v85
    v_mfma_f32_4x4x4_16b_bf16 v[68:71], v[36:37], v[246:247], v[68:71]
    v_cvt_pk_bf16_f32 v95, v82, v83
    v_mfma_f32_4x4x4_16b_bf16 v[64:67], v[16:17], v[226:227], v[64:67]
    v_mfma_f32_4x4x4_16b_bf16 v[72:75], v[34:35], v[246:247], v[72:75]
    v_mul_f32 v86, v102, v86
    v_mfma_f32_4x4x4_16b_bf16 v[60:63], v[20:21], v[228:229], v[60:63]
    v_mul_f32 v87, v103, v87
    v_mfma_f32_4x4x4_16b_bf16 v[68:71], v[38:39], v[248:249], v[68:71]
    v_mfma_f32_4x4x4_16b_bf16 v[64:67], v[18:19], v[228:229], v[64:67]
    v_cvt_pk_bf16_f32 v100, v84, v85
    v_mfma_f32_4x4x4_16b_bf16 v[72:75], v[36:37], v[248:249], v[72:75]
    v_mul_f32 v88, v104, v88
    v_mfma_f32_4x4x4_16b_bf16 v[60:63], v[22:23], v[230:231], v[60:63]
    v_mfma_f32_4x4x4_16b_bf16 v[68:71], v[40:41], v[250:251], v[68:71]
    v_mul_f32 v89, v105, v89
    v_mfma_f32_4x4x4_16b_bf16 v[64:67], v[20:21], v[230:231], v[64:67]
    v_cvt_pk_bf16_f32 v101, v86, v87
    v_mfma_f32_4x4x4_16b_bf16 v[72:75], v[38:39], v[250:251], v[72:75]
    v_mfma_f32_4x4x4_16b_bf16 v[60:63], v[24:25], v[232:233], v[60:63]
    v_mul_f32 v90, v106, v90
    v_mfma_f32_4x4x4_16b_bf16 v[68:71], v[42:43], v[252:253], v[68:71]
    v_mul_f32 v91, v107, v91
    v_mfma_f32_4x4x4_16b_bf16 v[64:67], v[22:23], v[232:233], v[64:67]
    v_mfma_f32_4x4x4_16b_bf16 v[72:75], v[40:41], v[252:253], v[72:75]
    v_cvt_pk_bf16_f32 v102, v88, v89
    v_mfma_f32_4x4x4_16b_bf16 v[64:67], v[24:25], v[234:235], v[64:67]
    v_cvt_pk_bf16_f32 v103, v90, v91
    v_mfma_f32_4x4x4_16b_bf16 v[72:75], v[42:43], v[254:255], v[72:75]
    s_setprio 1
    ds_write_b128 v4, v[92:95] offset:16384
    ds_write_b128 v4, v[100:103] offset:17408
    s_setprio 1
    s_waitcnt vmcnt(17) lgkmcnt(6)
    v_mfma_f32_16x16x32_bf16 v[76:79], v[128:131], v[108:111], 0
    v_mfma_f32_16x16x32_bf16 v[76:79], v[144:147], v[112:115], v[76:79]
    buffer_load_dwordx4 v[216:219], v4, s[24:27], s10 offen offset:2048 sc1
    s_waitcnt vmcnt(17)
    v_mfma_f32_16x16x32_bf16 v[80:83], v[132:135], v[108:111], 0
    v_exp_f32 v44, v60
    v_mfma_f32_16x16x32_bf16 v[80:83], v[148:151], v[112:115], v[80:83]
    s_setprio 2
    buffer_load_dwordx4 v[220:223], v4, s[24:27], s10 offen offset:3072 sc1
    s_add_u32 s10, s10, 4096
    s_waitcnt vmcnt(17)
    v_mfma_f32_16x16x32_bf16 v[84:87], v[136:139], v[108:111], 0
    v_exp_f32 v45, v61
    v_mfma_f32_16x16x32_bf16 v[84:87], v[152:155], v[112:115], v[84:87]
    v_exp_f32 v46, v62
    v_exp_f32 v47, v63
    s_waitcnt vmcnt(16)
    v_mfma_f32_16x16x32_bf16 v[88:91], v[140:143], v[108:111], 0
    ds_read_b64_tr_b16 v[108:109], v1 offset:4096
    ds_read_b64_tr_b16 v[110:111], v1 offset:5120
    v_mfma_f32_16x16x32_bf16 v[88:91], v[156:159], v[112:115], v[88:91]
    ds_read_b64_tr_b16 v[112:113], v1 offset:6144
    ds_read_b64_tr_b16 v[114:115], v1 offset:7168
    v_fma_f32 v44, v44, s37, s37
    s_waitcnt lgkmcnt(6)
    v_mfma_f32_16x16x32_bf16 v[92:95], v[128:131], v[116:119], 0
    v_fma_f32 v45, v45, s37, s37
    v_mfma_f32_16x16x32_bf16 v[92:95], v[144:147], v[120:123], v[92:95]
    buffer_load_dwordx4 v[224:227], v4, s[24:27], s10 offen offset:0 sc1
    v_mfma_f32_16x16x32_bf16 v[96:99], v[132:135], v[116:119], 0
    v_exp_f32 v48, v64
    v_mfma_f32_16x16x32_bf16 v[96:99], v[148:151], v[120:123], v[96:99]
    s_mov_b64 exec, s[0:1]
    ds_write_b32 v7, v7 offset:160
    s_mov_b64 exec, -1
    v_exp_f32 v49, v65
    v_fma_f32 v46, v46, s37, s37
    v_fma_f32 v47, v47, s37, s37
    v_mfma_f32_16x16x32_bf16 v[100:103], v[136:139], v[116:119], 0
    v_exp_f32 v50, v66
    v_mfma_f32_16x16x32_bf16 v[100:103], v[152:155], v[120:123], v[100:103]
    buffer_load_dwordx4 v[228:231], v4, s[24:27], s10 offen offset:1024 sc1
    v_mfma_f32_16x16x32_bf16 v[104:107], v[140:143], v[116:119], 0
    ds_read_b64_tr_b16 v[116:117], v0 offset:4096
    ds_read_b64_tr_b16 v[118:119], v0 offset:5120
    v_mfma_f32_16x16x32_bf16 v[104:107], v[156:159], v[120:123], v[104:107]
    ds_read_b64_tr_b16 v[120:121], v0 offset:6144
    ds_read_b64_tr_b16 v[122:123], v0 offset:7168
    v_exp_f32 v51, v67
    s_waitcnt vmcnt(13) lgkmcnt(5)
    v_mfma_f32_16x16x32_bf16 v[76:79], v[160:163], v[108:111], v[76:79]
    v_mfma_f32_16x16x32_bf16 v[76:79], v[176:179], v[112:115], v[76:79]
    buffer_load_dwordx4 v[232:235], v4, s[24:27], s10 offen offset:2048 sc1
    s_waitcnt vmcnt(13)
    v_mfma_f32_16x16x32_bf16 v[80:83], v[164:167], v[108:111], v[80:83]
    v_fma_f32 v48, v48, s37, s37
    v_fma_f32 v49, v49, s37, s37
    v_mfma_f32_16x16x32_bf16 v[80:83], v[180:183], v[112:115], v[80:83]
    buffer_load_dwordx4 v[236:239], v4, s[24:27], s10 offen offset:3072 sc1
    s_add_u32 s10, s10, 4096
    s_waitcnt vmcnt(13)
    v_mfma_f32_16x16x32_bf16 v[84:87], v[168:171], v[108:111], v[84:87]
    v_exp_f32 v52, v68
    v_mfma_f32_16x16x32_bf16 v[84:87], v[184:187], v[112:115], v[84:87]
    v_exp_f32 v53, v69
    v_fma_f32 v50, v50, s37, s37
    v_fma_f32 v51, v51, s37, s37
    s_waitcnt vmcnt(12)
    v_mfma_f32_16x16x32_bf16 v[88:91], v[172:175], v[108:111], v[88:91]
    ds_read_b64_tr_b16 v[108:109], v1 offset:8192
    ds_read_b64_tr_b16 v[110:111], v1 offset:9216
    v_mfma_f32_16x16x32_bf16 v[88:91], v[188:191], v[112:115], v[88:91]
    ds_read_b64_tr_b16 v[112:113], v1 offset:10240
    ds_read_b64_tr_b16 v[114:115], v1 offset:11264
    v_exp_f32 v54, v70
    s_waitcnt lgkmcnt(4)
    v_mfma_f32_16x16x32_bf16 v[92:95], v[160:163], v[116:119], v[92:95]
    v_mfma_f32_16x16x32_bf16 v[92:95], v[176:179], v[120:123], v[92:95]
    buffer_load_dwordx4 v[240:243], v4, s[24:27], s10 offen offset:0 sc1
    v_exp_f32 v55, v71
    v_mfma_f32_16x16x32_bf16 v[96:99], v[164:167], v[116:119], v[96:99]
    v_fma_f32 v52, v52, s37, s37
    v_mfma_f32_16x16x32_bf16 v[96:99], v[180:183], v[120:123], v[96:99]
    buffer_load_dwordx4 v[244:247], v4, s[24:27], s10 offen offset:1024 sc1
    v_fma_f32 v53, v53, s37, s37
    v_mfma_f32_16x16x32_bf16 v[100:103], v[168:171], v[116:119], v[100:103]
    v_exp_f32 v56, v72
    v_mfma_f32_16x16x32_bf16 v[100:103], v[184:187], v[120:123], v[100:103]
    v_exp_f32 v57, v73
    v_fma_f32 v54, v54, s37, s37
    v_fma_f32 v55, v55, s37, s37
    v_mfma_f32_16x16x32_bf16 v[104:107], v[172:175], v[116:119], v[104:107]
    ds_read_b64_tr_b16 v[116:117], v0 offset:8192
    ds_read_b64_tr_b16 v[118:119], v0 offset:9216
    v_mfma_f32_16x16x32_bf16 v[104:107], v[188:191], v[120:123], v[104:107]
    ds_read_b64_tr_b16 v[120:121], v0 offset:10240
    ds_read_b64_tr_b16 v[122:123], v0 offset:11264
    v_exp_f32 v58, v74
    s_waitcnt vmcnt(9) lgkmcnt(4)
    v_mfma_f32_16x16x32_bf16 v[76:79], v[192:195], v[108:111], v[76:79]
    v_mfma_f32_16x16x32_bf16 v[76:79], v[208:211], v[112:115], v[76:79]
    buffer_load_dwordx4 v[248:251], v4, s[24:27], s10 offen offset:2048 sc1
    v_exp_f32 v59, v75
    s_waitcnt vmcnt(9)
    v_mfma_f32_16x16x32_bf16 v[80:83], v[196:199], v[108:111], v[80:83]
    v_fma_f32 v56, v56, s37, s37
    v_mfma_f32_16x16x32_bf16 v[80:83], v[212:215], v[112:115], v[80:83]
    buffer_load_dwordx4 v[252:255], v4, s[24:27], s10 offen offset:3072 sc1
    s_add_u32 s10, s10, 4096
    v_fma_f32 v57, v57, s37, s37
    s_waitcnt vmcnt(9)
    v_mfma_f32_16x16x32_bf16 v[84:87], v[200:203], v[108:111], v[84:87]
    v_fma_f32 v58, v58, s37, s37
    v_fma_f32 v59, v59, s37, s37
    v_mfma_f32_16x16x32_bf16 v[84:87], v[216:219], v[112:115], v[84:87]
    v_rcp_f32 v44, v44
    v_rcp_f32 v45, v45
    s_waitcnt vmcnt(8)
    v_mfma_f32_16x16x32_bf16 v[88:91], v[204:207], v[108:111], v[88:91]
    ds_read_b64_tr_b16 v[108:109], v1 offset:12288
    ds_read_b64_tr_b16 v[110:111], v1 offset:13312
    v_mfma_f32_16x16x32_bf16 v[88:91], v[220:223], v[112:115], v[88:91]
    ds_read_b64_tr_b16 v[112:113], v1 offset:14336
    ds_read_b64_tr_b16 v[114:115], v1 offset:15360
    v_rcp_f32 v46, v46
    s_waitcnt lgkmcnt(4)
    v_mfma_f32_16x16x32_bf16 v[92:95], v[192:195], v[116:119], v[92:95]
    ds_read_b32 v6, v7 offset:160
    v_mfma_f32_16x16x32_bf16 v[92:95], v[208:211], v[120:123], v[92:95]
    v_rcp_f32 v47, v47
    v_mul_f32 v44, v60, v44
    v_mul_f32 v45, v61, v45
    v_mfma_f32_16x16x32_bf16 v[96:99], v[196:199], v[116:119], v[96:99]
    v_rcp_f32 v48, v48
    v_mfma_f32_16x16x32_bf16 v[96:99], v[212:215], v[120:123], v[96:99]
    v_rcp_f32 v49, v49
    v_mul_f32 v46, v62, v46
    v_mul_f32 v47, v63, v47
    v_mfma_f32_16x16x32_bf16 v[100:103], v[200:203], v[116:119], v[100:103]
    v_rcp_f32 v50, v50
    v_mfma_f32_16x16x32_bf16 v[100:103], v[216:219], v[120:123], v[100:103]
    s_waitcnt lgkmcnt(0)
    v_cmp_eq_u32 vcc, 0, v6
    s_and_b32 s34, vcc_lo, 15
    s_cbranch_scc1 L_wL5s
L_wL5:
    v_cvt_pk_bf16_f32 v60, v44, v45
    v_mul_f32 v48, v64, v48
    v_mfma_f32_16x16x32_bf16 v[104:107], v[204:207], v[116:119], v[104:107]
    ds_read_b64_tr_b16 v[116:117], v0 offset:12288
    ds_read_b64_tr_b16 v[118:119], v0 offset:13312
    v_mfma_f32_16x16x32_bf16 v[104:107], v[220:223], v[120:123], v[104:107]
    ds_read_b64_tr_b16 v[120:121], v0 offset:14336
    ds_read_b64_tr_b16 v[122:123], v0 offset:15360
    v_rcp_f32 v51, v51
    s_waitcnt vmcnt(3)
    v_mfma_f32_16x16x32_bf16 v[76:79], v[224:227], v[108:111], v[76:79]
    v_mfma_f32_16x16x32_bf16 v[76:79], v[240:243], v[112:115], v[76:79]
    v_mul_f32 v49, v65, v49
    v_cvt_pk_bf16_f32 v61, v46, v47
    v_rcp_f32 v52, v52
    s_waitcnt vmcnt(2)
    v_mfma_f32_16x16x32_bf16 v[80:83], v[228:231], v[108:111], v[80:83]
    v_rcp_f32 v53, v53
    v_mfma_f32_16x16x32_bf16 v[80:83], v[244:247], v[112:115], v[80:83]
    v_mul_f32 v50, v66, v50
    v_mul_f32 v51, v67, v51
    v_rcp_f32 v54, v54
    s_waitcnt vmcnt(1)
    v_mfma_f32_16x16x32_bf16 v[84:87], v[232:235], v[108:111], v[84:87]
    v_cvt_pk_bf16_f32 v62, v48, v49
    v_mul_f32 v52, v68, v52
    v_mfma_f32_16x16x32_bf16 v[84:87], v[248:251], v[112:115], v[84:87]
    v_rcp_f32 v55, v55
    v_mul_f32 v53, v69, v53
    v_cvt_pk_bf16_f32 v63, v50, v51
    s_waitcnt vmcnt(0)
    v_mfma_f32_16x16x32_bf16 v[88:91], v[236:239], v[108:111], v[88:91]
    ds_read_b64_tr_b16 v[108:109], v1 offset:16384
    ds_read_b64_tr_b16 v[110:111], v1 offset:17408
    v_mfma_f32_16x16x32_bf16 v[88:91], v[252:255], v[112:115], v[88:91]
    ds_read_b64_tr_b16 v[112:113], v1 offset:20480
    ds_read_b64_tr_b16 v[114:115], v1 offset:21504
    v_rcp_f32 v56, v56
    s_waitcnt lgkmcnt(4)
    v_mfma_f32_16x16x32_bf16 v[92:95], v[224:227], v[116:119], v[92:95]
    v_mfma_f32_16x16x32_bf16 v[92:95], v[240:243], v[120:123], v[92:95]
    v_rcp_f32 v57, v57
    v_mul_f32 v54, v70, v54
    v_mul_f32 v55, v71, v55
    v_mfma_f32_16x16x32_bf16 v[96:99], v[228:231], v[116:119], v[96:99]
    v_rcp_f32 v58, v58
    v_mfma_f32_16x16x32_bf16 v[96:99], v[244:247], v[120:123], v[96:99]
    v_cvt_pk_bf16_f32 v68, v52, v53
    v_mul_f32 v56, v72, v56
    v_rcp_f32 v59, v59
    v_mfma_f32_16x16x32_bf16 v[100:103], v[232:235], v[116:119], v[100:103]
    v_mul_f32 v57, v73, v57
    v_cvt_pk_bf16_f32 v69, v54, v55
    v_mfma_f32_16x16x32_bf16 v[100:103], v[248:251], v[120:123], v[100:103]
    v_xor_b32 v126, 64, v127
    v_add_u32 v125, s9, v4
    v_mul_f32 v58, v74, v58
    v_mul_f32 v59, v75, v59
    v_cvt_pk_bf16_f32 v70, v56, v57
    v_cvt_pk_bf16_f32 v71, v58, v59
    v_mfma_f32_16x16x32_bf16 v[104:107], v[236:239], v[116:119], v[104:107]
    ds_read_b64_tr_b16 v[116:117], v0 offset:16384
    ds_read_b64_tr_b16 v[118:119], v0 offset:17408
    v_mfma_f32_16x16x32_bf16 v[104:107], v[252:255], v[120:123], v[104:107]
    ds_read_b64_tr_b16 v[120:121], v0 offset:20480
    ds_read_b64_tr_b16 v[122:123], v0 offset:21504
    s_setprio 1
    ds_write_b128 v4, v[60:63] offset:32768
    ds_write_b128 v4, v[68:71] offset:33792
    s_setprio 2
    s_waitcnt lgkmcnt(6)
    v_mfma_f32_16x16x32_bf16 v[44:47], v[128:131], v[108:111], 0
    v_mfma_f32_16x16x32_bf16 v[44:47], v[160:163], v[112:115], v[44:47]
    v_cvt_pk_bf16_f32 v8, v76, v77
    v_cvt_pk_bf16_f32 v9, v78, v79
    v_mfma_f32_16x16x32_bf16 v[48:51], v[132:135], v[108:111], 0
    v_cvt_pk_bf16_f32 v10, v80, v81
    v_cvt_pk_bf16_f32 v11, v82, v83
    v_mfma_f32_16x16x32_bf16 v[48:51], v[164:167], v[112:115], v[48:51]
    v_cvt_pk_bf16_f32 v12, v84, v85
    v_cvt_pk_bf16_f32 v13, v86, v87
    v_mfma_f32_16x16x32_bf16 v[52:55], v[136:139], v[108:111], 0
    v_cvt_pk_bf16_f32 v14, v88, v89
    v_cvt_pk_bf16_f32 v15, v90, v91
    v_mfma_f32_16x16x32_bf16 v[52:55], v[168:171], v[112:115], v[52:55]
    s_mov_b32 s12, 0
    s_mov_b32 s13, 4096
    v_mfma_f32_16x16x32_bf16 v[56:59], v[140:143], v[108:111], 0
    ds_read_b64_tr_b16 v[108:109], v1 offset:24576
    ds_read_b64_tr_b16 v[110:111], v1 offset:25600
    v_mfma_f32_16x16x32_bf16 v[56:59], v[172:175], v[112:115], v[56:59]
    ds_read_b64_tr_b16 v[112:113], v1 offset:28672
    ds_read_b64_tr_b16 v[114:115], v1 offset:29696
    s_waitcnt lgkmcnt(6)
    v_mfma_f32_16x16x32_bf16 v[60:63], v[128:131], v[116:119], 0
    v_mfma_f32_16x16x32_bf16 v[60:63], v[160:163], v[120:123], v[60:63]
    ds_write_b128 v127, v[8:11] offset:0
    v_mfma_f32_16x16x32_bf16 v[64:67], v[132:135], v[116:119], 0
    v_mfma_f32_16x16x32_bf16 v[64:67], v[164:167], v[120:123], v[64:67]
    v_cvt_pk_bf16_f32 v16, v92, v93
    v_cvt_pk_bf16_f32 v17, v94, v95
    v_mfma_f32_16x16x32_bf16 v[68:71], v[136:139], v[116:119], 0
    v_cvt_pk_bf16_f32 v18, v96, v97
    v_cvt_pk_bf16_f32 v19, v98, v99
    v_mfma_f32_16x16x32_bf16 v[68:71], v[168:171], v[120:123], v[68:71]
    s_mov_b32 s14, 8192
    s_mov_b32 s15, 12288
    v_mfma_f32_16x16x32_bf16 v[72:75], v[140:143], v[116:119], 0
    ds_read_b64_tr_b16 v[116:117], v0 offset:24576
    ds_read_b64_tr_b16 v[118:119], v0 offset:25600
    v_mfma_f32_16x16x32_bf16 v[72:75], v[172:175], v[120:123], v[72:75]
    ds_read_b64_tr_b16 v[120:121], v0 offset:28672
    ds_read_b64_tr_b16 v[122:123], v0 offset:29696
    ds_read_b32 v6, v7 offset:160
    s_waitcnt lgkmcnt(6)
    v_mfma_f32_16x16x32_bf16 v[44:47], v[192:195], v[108:111], v[44:47]
    v_mfma_f32_16x16x32_bf16 v[44:47], v[224:227], v[112:115], v[44:47]
    ds_write_b128 v126, v[12:15] offset:0
    v_mfma_f32_16x16x32_bf16 v[48:51], v[196:199], v[108:111], v[48:51]
    v_mfma_f32_16x16x32_bf16 v[48:51], v[228:231], v[112:115], v[48:51]
    s_waitcnt lgkmcnt(1)
    v_cmp_eq_u32 vcc, 0, v6
    s_and_b32 s34, vcc_lo, 240
    s_cbranch_scc1 L_wL13s
L_wL13:
    v_mfma_f32_16x16x32_bf16 v[52:55], v[200:203], v[108:111], v[52:55]
    v_mfma_f32_16x16x32_bf16 v[52:55], v[232:235], v[112:115], v[52:55]
    s_mov_b64 exec, s[0:1]
    ds_write_b32 v7, v7 offset:0
    s_mov_b64 exec, -1
    v_mfma_f32_16x16x32_bf16 v[56:59], v[204:207], v[108:111], v[56:59]
    ds_read_b64_tr_b16 v[108:109], v1 offset:18432
    ds_read_b64_tr_b16 v[110:111], v1 offset:19456
    v_mfma_f32_16x16x32_bf16 v[56:59], v[236:239], v[112:115], v[56:59]
    ds_read_b64_tr_b16 v[112:113], v1 offset:22528
    ds_read_b64_tr_b16 v[114:115], v1 offset:23552
    v_mfma_f32_16x16x32_bf16 v[60:63], v[192:195], v[116:119], v[60:63]
    v_mfma_f32_16x16x32_bf16 v[60:63], v[224:227], v[120:123], v[60:63]
    ds_read_b128 v[24:27], v125 offset:0
    v_mfma_f32_16x16x32_bf16 v[64:67], v[196:199], v[116:119], v[64:67]
    ds_read_b128 v[28:31], v125 offset:1024
    v_mfma_f32_16x16x32_bf16 v[64:67], v[228:231], v[120:123], v[64:67]
    v_cvt_pk_bf16_f32 v20, v100, v101
    v_cvt_pk_bf16_f32 v21, v102, v103
    v_mfma_f32_16x16x32_bf16 v[68:71], v[200:203], v[116:119], v[68:71]
    v_cvt_pk_bf16_f32 v22, v104, v105
    v_cvt_pk_bf16_f32 v23, v106, v107
    v_mfma_f32_16x16x32_bf16 v[68:71], v[232:235], v[120:123], v[68:71]
    v_mfma_f32_16x16x32_bf16 v[72:75], v[204:207], v[116:119], v[72:75]
    ds_read_b64_tr_b16 v[116:117], v0 offset:18432
    ds_read_b64_tr_b16 v[118:119], v0 offset:19456
    v_mfma_f32_16x16x32_bf16 v[72:75], v[236:239], v[120:123], v[72:75]
    ds_read_b64_tr_b16 v[120:121], v0 offset:22528
    ds_read_b64_tr_b16 v[122:123], v0 offset:23552
    s_waitcnt lgkmcnt(6)
    v_mfma_f32_16x16x32_bf16 v[44:47], v[144:147], v[108:111], v[44:47]
    v_mfma_f32_16x16x32_bf16 v[44:47], v[176:179], v[112:115], v[44:47]
    ds_write_b128 v127, v[16:19] offset:2048
    v_mfma_f32_16x16x32_bf16 v[48:51], v[148:151], v[108:111], v[48:51]
    v_mfma_f32_16x16x32_bf16 v[48:51], v[180:183], v[112:115], v[48:51]
    s_waitcnt lgkmcnt(6)
    buffer_store_dwordx4 v[24:27], v5, s[20:23], s12 offen sc1 nt
    v_mfma_f32_16x16x32_bf16 v[52:55], v[152:155], v[108:111], v[52:55]
    v_mfma_f32_16x16x32_bf16 v[52:55], v[184:187], v[112:115], v[52:55]
    v_mfma_f32_16x16x32_bf16 v[56:59], v[156:159], v[108:111], v[56:59]
    ds_read_b64_tr_b16 v[108:109], v1 offset:26624
    ds_read_b64_tr_b16 v[110:111], v1 offset:27648
    v_mfma_f32_16x16x32_bf16 v[56:59], v[188:191], v[112:115], v[56:59]
    ds_read_b64_tr_b16 v[112:113], v1 offset:30720
    ds_read_b64_tr_b16 v[114:115], v1 offset:31744
    s_waitcnt lgkmcnt(5)
    v_mfma_f32_16x16x32_bf16 v[60:63], v[144:147], v[116:119], v[60:63]
    v_mfma_f32_16x16x32_bf16 v[60:63], v[176:179], v[120:123], v[60:63]
    ds_write_b128 v126, v[20:23] offset:2048
    v_mfma_f32_16x16x32_bf16 v[64:67], v[148:151], v[116:119], v[64:67]
    v_mfma_f32_16x16x32_bf16 v[64:67], v[180:183], v[120:123], v[64:67]
    v_mfma_f32_16x16x32_bf16 v[68:71], v[152:155], v[116:119], v[68:71]
    v_mfma_f32_16x16x32_bf16 v[68:71], v[184:187], v[120:123], v[68:71]
    buffer_store_dwordx4 v[28:31], v5, s[20:23], s13 offen sc1 nt
    v_mfma_f32_16x16x32_bf16 v[72:75], v[156:159], v[116:119], v[72:75]
    ds_read_b64_tr_b16 v[116:117], v0 offset:26624
    ds_read_b64_tr_b16 v[118:119], v0 offset:27648
    v_mfma_f32_16x16x32_bf16 v[72:75], v[188:191], v[120:123], v[72:75]
    ds_read_b64_tr_b16 v[120:121], v0 offset:30720
    ds_read_b64_tr_b16 v[122:123], v0 offset:31744
    ds_read_b32 v6, v7 offset:0
    s_waitcnt lgkmcnt(6)
    v_mfma_f32_16x16x32_bf16 v[44:47], v[208:211], v[108:111], v[44:47]
    v_mfma_f32_16x16x32_bf16 v[44:47], v[240:243], v[112:115], v[44:47]
    ds_read_b128 v[32:35], v125 offset:2048
    v_mfma_f32_16x16x32_bf16 v[48:51], v[212:215], v[108:111], v[48:51]
    ds_read_b128 v[36:39], v125 offset:3072
    v_mfma_f32_16x16x32_bf16 v[48:51], v[244:247], v[112:115], v[48:51]
    s_waitcnt lgkmcnt(2)
    v_cmp_eq_u32 vcc, 0, v6
    s_and_b32 s34, vcc_lo, 15
    s_cbranch_scc1 L_wL0s
L_wL0:
    v_mfma_f32_16x16x32_bf16 v[52:55], v[216:219], v[108:111], v[52:55]
    v_mfma_f32_16x16x32_bf16 v[52:55], v[248:251], v[112:115], v[52:55]
    v_mfma_f32_16x16x32_bf16 v[56:59], v[220:223], v[108:111], v[56:59]
    ds_read_b64_tr_b16 v[108:109], v1 offset:32768
    ds_read_b64_tr_b16 v[110:111], v1 offset:33792
    v_mfma_f32_16x16x32_bf16 v[56:59], v[252:255], v[112:115], v[56:59]
    ds_read_b64_tr_b16 v[112:113], v1 offset:36864
    ds_read_b64_tr_b16 v[114:115], v1 offset:37888
    v_mfma_f32_16x16x32_bf16 v[60:63], v[208:211], v[116:119], v[60:63]
    v_mfma_f32_16x16x32_bf16 v[60:63], v[240:243], v[120:123], v[60:63]
    s_waitcnt lgkmcnt(5)
    buffer_store_dwordx4 v[32:35], v5, s[20:23], s14 offen sc1 nt
    v_mfma_f32_16x16x32_bf16 v[64:67], v[212:215], v[116:119], v[64:67]
    v_mfma_f32_16x16x32_bf16 v[64:67], v[244:247], v[120:123], v[64:67]
    s_waitcnt lgkmcnt(4)
    buffer_store_dwordx4 v[36:39], v5, s[20:23], s15 offen sc1 nt
    v_mfma_f32_16x16x32_bf16 v[68:71], v[216:219], v[116:119], v[68:71]
    v_mfma_f32_16x16x32_bf16 v[68:71], v[248:251], v[120:123], v[68:71]
    v_mfma_f32_16x16x32_bf16 v[72:75], v[220:223], v[116:119], v[72:75]
    ds_read_b64_tr_b16 v[116:117], v0 offset:32768
    ds_read_b64_tr_b16 v[118:119], v0 offset:33792
    v_mfma_f32_16x16x32_bf16 v[72:75], v[252:255], v[120:123], v[72:75]
    ds_read_b64_tr_b16 v[120:121], v0 offset:36864
    ds_read_b64_tr_b16 v[122:123], v0 offset:37888
    s_setprio 2
    s_waitcnt lgkmcnt(4)
    v_mfma_f32_16x16x32_bf16 v[76:79], v[128:131], v[108:111], 0
    v_mfma_f32_16x16x32_bf16 v[76:79], v[160:163], v[112:115], v[76:79]
    v_cvt_pk_bf16_f32 v8, v44, v45
    v_cvt_pk_bf16_f32 v9, v46, v47
    v_mfma_f32_16x16x32_bf16 v[80:83], v[132:135], v[108:111], 0
    v_cvt_pk_bf16_f32 v10, v48, v49
    v_cvt_pk_bf16_f32 v11, v50, v51
    v_mfma_f32_16x16x32_bf16 v[80:83], v[164:167], v[112:115], v[80:83]
    v_cvt_pk_bf16_f32 v12, v52, v53
    v_cvt_pk_bf16_f32 v13, v54, v55
    v_mfma_f32_16x16x32_bf16 v[84:87], v[136:139], v[108:111], 0
    v_cvt_pk_bf16_f32 v14, v56, v57
    v_cvt_pk_bf16_f32 v15, v58, v59
    v_mfma_f32_16x16x32_bf16 v[84:87], v[168:171], v[112:115], v[84:87]
    s_mov_b32 s12, 16384
    s_mov_b32 s13, 20480
    v_mfma_f32_16x16x32_bf16 v[88:91], v[140:143], v[108:111], 0
    ds_read_b64_tr_b16 v[108:109], v1 offset:40960
    ds_read_b64_tr_b16 v[110:111], v1 offset:41984
    v_mfma_f32_16x16x32_bf16 v[88:91], v[172:175], v[112:115], v[88:91]
    ds_read_b64_tr_b16 v[112:113], v1 offset:45056
    ds_read_b64_tr_b16 v[114:115], v1 offset:46080
    s_waitcnt lgkmcnt(4)
    v_mfma_f32_16x16x32_bf16 v[92:95], v[128:131], v[116:119], 0
    v_mfma_f32_16x16x32_bf16 v[92:95], v[160:163], v[120:123], v[92:95]
    ds_write_b128 v127, v[8:11] offset:0
    v_mfma_f32_16x16x32_bf16 v[96:99], v[132:135], v[116:119], 0
    v_mfma_f32_16x16x32_bf16 v[96:99], v[164:167], v[120:123], v[96:99]
    v_cvt_pk_bf16_f32 v16, v60, v61
    v_cvt_pk_bf16_f32 v17, v62, v63
    v_mfma_f32_16x16x32_bf16 v[100:103], v[136:139], v[116:119], 0
    v_cvt_pk_bf16_f32 v18, v64, v65
    v_cvt_pk_bf16_f32 v19, v66, v67
    v_mfma_f32_16x16x32_bf16 v[100:103], v[168:171], v[120:123], v[100:103]
    s_mov_b32 s14, 24576
    s_mov_b32 s15, 28672
    v_mfma_f32_16x16x32_bf16 v[104:107], v[140:143], v[116:119], 0
    ds_read_b64_tr_b16 v[116:117], v0 offset:40960
    ds_read_b64_tr_b16 v[118:119], v0 offset:41984
    v_mfma_f32_16x16x32_bf16 v[104:107], v[172:175], v[120:123], v[104:107]
    ds_read_b64_tr_b16 v[120:121], v0 offset:45056
    ds_read_b64_tr_b16 v[122:123], v0 offset:46080
    ds_read_b32 v6, v7 offset:0
    s_waitcnt lgkmcnt(6)
    v_mfma_f32_16x16x32_bf16 v[76:79], v[192:195], v[108:111], v[76:79]
    v_mfma_f32_16x16x32_bf16 v[76:79], v[224:227], v[112:115], v[76:79]
    ds_write_b128 v126, v[12:15] offset:0
    v_mfma_f32_16x16x32_bf16 v[80:83], v[196:199], v[108:111], v[80:83]
    v_mfma_f32_16x16x32_bf16 v[80:83], v[228:231], v[112:115], v[80:83]
    s_waitcnt lgkmcnt(1)
    v_cmp_eq_u32 vcc, 0, v6
    s_and_b32 s34, vcc_lo, 240
    s_cbranch_scc1 L_wL8s
L_wL8:
    v_mfma_f32_16x16x32_bf16 v[84:87], v[200:203], v[108:111], v[84:87]
    v_mfma_f32_16x16x32_bf16 v[84:87], v[232:235], v[112:115], v[84:87]
    v_mfma_f32_16x16x32_bf16 v[88:91], v[204:207], v[108:111], v[88:91]
    ds_read_b64_tr_b16 v[108:109], v1 offset:34816
    ds_read_b64_tr_b16 v[110:111], v1 offset:35840
    v_mfma_f32_16x16x32_bf16 v[88:91], v[236:239], v[112:115], v[88:91]
    ds_read_b64_tr_b16 v[112:113], v1 offset:38912
    ds_read_b64_tr_b16 v[114:115], v1 offset:39936
    v_mfma_f32_16x16x32_bf16 v[92:95], v[192:195], v[116:119], v[92:95]
    v_mfma_f32_16x16x32_bf16 v[92:95], v[224:227], v[120:123], v[92:95]
    ds_read_b128 v[24:27], v125 offset:0
    v_mfma_f32_16x16x32_bf16 v[96:99], v[196:199], v[116:119], v[96:99]
    ds_read_b128 v[28:31], v125 offset:1024
    v_mfma_f32_16x16x32_bf16 v[96:99], v[228:231], v[120:123], v[96:99]
    v_cvt_pk_bf16_f32 v20, v68, v69
    v_cvt_pk_bf16_f32 v21, v70, v71
    v_mfma_f32_16x16x32_bf16 v[100:103], v[200:203], v[116:119], v[100:103]
    v_cvt_pk_bf16_f32 v22, v72, v73
    v_cvt_pk_bf16_f32 v23, v74, v75
    v_mfma_f32_16x16x32_bf16 v[100:103], v[232:235], v[120:123], v[100:103]
    v_mfma_f32_16x16x32_bf16 v[104:107], v[204:207], v[116:119], v[104:107]
    ds_read_b64_tr_b16 v[116:117], v0 offset:34816
    ds_read_b64_tr_b16 v[118:119], v0 offset:35840
    v_mfma_f32_16x16x32_bf16 v[104:107], v[236:239], v[120:123], v[104:107]
    ds_read_b64_tr_b16 v[120:121], v0 offset:38912
    ds_read_b64_tr_b16 v[122:123], v0 offset:39936
    s_waitcnt lgkmcnt(6)
    v_mfma_f32_16x16x32_bf16 v[76:79], v[144:147], v[108:111], v[76:79]
    v_mfma_f32_16x16x32_bf16 v[76:79], v[176:179], v[112:115], v[76:79]
    ds_write_b128 v127, v[16:19] offset:2048
    v_mfma_f32_16x16x32_bf16 v[80:83], v[148:151], v[108:111], v[80:83]
    v_mfma_f32_16x16x32_bf16 v[80:83], v[180:183], v[112:115], v[80:83]
    s_waitcnt lgkmcnt(6)
    buffer_store_dwordx4 v[24:27], v5, s[20:23], s12 offen sc1 nt
    v_mfma_f32_16x16x32_bf16 v[84:87], v[152:155], v[108:111], v[84:87]
    v_mfma_f32_16x16x32_bf16 v[84:87], v[184:187], v[112:115], v[84:87]
    v_mfma_f32_16x16x32_bf16 v[88:91], v[156:159], v[108:111], v[88:91]
    ds_read_b64_tr_b16 v[108:109], v1 offset:43008
    ds_read_b64_tr_b16 v[110:111], v1 offset:44032
    v_mfma_f32_16x16x32_bf16 v[88:91], v[188:191], v[112:115], v[88:91]
    ds_read_b64_tr_b16 v[112:113], v1 offset:47104
    ds_read_b64_tr_b16 v[114:115], v1 offset:48128
    s_waitcnt lgkmcnt(5)
    v_mfma_f32_16x16x32_bf16 v[92:95], v[144:147], v[116:119], v[92:95]
    v_mfma_f32_16x16x32_bf16 v[92:95], v[176:179], v[120:123], v[92:95]
    ds_write_b128 v126, v[20:23] offset:2048
    v_mfma_f32_16x16x32_bf16 v[96:99], v[148:151], v[116:119], v[96:99]
    v_mfma_f32_16x16x32_bf16 v[96:99], v[180:183], v[120:123], v[96:99]
    v_mfma_f32_16x16x32_bf16 v[100:103], v[152:155], v[116:119], v[100:103]
    v_mfma_f32_16x16x32_bf16 v[100:103], v[184:187], v[120:123], v[100:103]
    buffer_store_dwordx4 v[28:31], v5, s[20:23], s13 offen sc1 nt
    v_mfma_f32_16x16x32_bf16 v[104:107], v[156:159], v[116:119], v[104:107]
    ds_read_b64_tr_b16 v[116:117], v0 offset:43008
    ds_read_b64_tr_b16 v[118:119], v0 offset:44032
    v_mfma_f32_16x16x32_bf16 v[104:107], v[188:191], v[120:123], v[104:107]
    ds_read_b64_tr_b16 v[120:121], v0 offset:47104
    ds_read_b64_tr_b16 v[122:123], v0 offset:48128
    ds_read_b32 v6, v7 offset:192
    s_waitcnt lgkmcnt(6)
    v_mfma_f32_16x16x32_bf16 v[76:79], v[208:211], v[108:111], v[76:79]
    v_mfma_f32_16x16x32_bf16 v[76:79], v[240:243], v[112:115], v[76:79]
    ds_read_b128 v[32:35], v125 offset:2048
    v_mfma_f32_16x16x32_bf16 v[80:83], v[212:215], v[108:111], v[80:83]
    ds_read_b128 v[36:39], v125 offset:3072
    v_mfma_f32_16x16x32_bf16 v[80:83], v[244:247], v[112:115], v[80:83]
    s_waitcnt lgkmcnt(2)
    v_cmp_eq_u32 vcc, 0, v6
    s_and_b32 s34, vcc_lo, 240
    s_cbranch_scc1 L_wL6s
L_wL6:
    v_mfma_f32_16x16x32_bf16 v[84:87], v[216:219], v[108:111], v[84:87]
    v_mfma_f32_16x16x32_bf16 v[84:87], v[248:251], v[112:115], v[84:87]
    v_mfma_f32_16x16x32_bf16 v[88:91], v[220:223], v[108:111], v[88:91]
    ds_read_b64_tr_b16 v[108:109], v1 offset:51200
    ds_read_b64_tr_b16 v[110:111], v1 offset:52224
    v_mfma_f32_16x16x32_bf16 v[88:91], v[252:255], v[112:115], v[88:91]
    ds_read_b64_tr_b16 v[112:113], v1 offset:55296
    ds_read_b64_tr_b16 v[114:115], v1 offset:56320
    v_mfma_f32_16x16x32_bf16 v[92:95], v[208:211], v[116:119], v[92:95]
    v_mfma_f32_16x16x32_bf16 v[92:95], v[240:243], v[120:123], v[92:95]
    s_waitcnt lgkmcnt(5)
    buffer_store_dwordx4 v[32:35], v5, s[20:23], s14 offen sc1 nt
    v_mfma_f32_16x16x32_bf16 v[96:99], v[212:215], v[116:119], v[96:99]
    v_mfma_f32_16x16x32_bf16 v[96:99], v[244:247], v[120:123], v[96:99]
    s_waitcnt lgkmcnt(4)
    buffer_store_dwordx4 v[36:39], v5, s[20:23], s15 offen sc1 nt
    v_mfma_f32_16x16x32_bf16 v[100:103], v[216:219], v[116:119], v[100:103]
    v_mfma_f32_16x16x32_bf16 v[100:103], v[248:251], v[120:123], v[100:103]
    v_mfma_f32_16x16x32_bf16 v[104:107], v[220:223], v[116:119], v[104:107]
    ds_read_b64_tr_b16 v[116:117], v0 offset:51200
    ds_read_b64_tr_b16 v[118:119], v0 offset:52224
    v_mfma_f32_16x16x32_bf16 v[104:107], v[252:255], v[120:123], v[104:107]
    ds_read_b64_tr_b16 v[120:121], v0 offset:55296
    ds_read_b64_tr_b16 v[122:123], v0 offset:56320
    s_setprio 2
    s_waitcnt lgkmcnt(4)
    v_mfma_f32_16x16x32_bf16 v[44:47], v[144:147], v[108:111], 0
    v_mfma_f32_16x16x32_bf16 v[44:47], v[176:179], v[112:115], v[44:47]
    v_cvt_pk_bf16_f32 v8, v76, v77
    v_cvt_pk_bf16_f32 v9, v78, v79
    v_mfma_f32_16x16x32_bf16 v[48:51], v[148:151], v[108:111], 0
    v_cvt_pk_bf16_f32 v10, v80, v81
    v_cvt_pk_bf16_f32 v11, v82, v83
    v_mfma_f32_16x16x32_bf16 v[48:51], v[180:183], v[112:115], v[48:51]
    v_cvt_pk_bf16_f32 v12, v84, v85
    v_cvt_pk_bf16_f32 v13, v86, v87
    v_mfma_f32_16x16x32_bf16 v[52:55], v[152:155], v[108:111], 0
    v_cvt_pk_bf16_f32 v14, v88, v89
    v_cvt_pk_bf16_f32 v15, v90, v91
    v_mfma_f32_16x16x32_bf16 v[52:55], v[184:187], v[112:115], v[52:55]
    s_mov_b32 s12, 32768
    s_mov_b32 s13, 36864
    v_mfma_f32_16x16x32_bf16 v[56:59], v[156:159], v[108:111], 0
    ds_read_b64_tr_b16 v[108:109], v1 offset:59392
    ds_read_b64_tr_b16 v[110:111], v1 offset:60416
    v_mfma_f32_16x16x32_bf16 v[56:59], v[188:191], v[112:115], v[56:59]
    ds_read_b64_tr_b16 v[112:113], v1 offset:63488
    ds_read_b64_tr_b16 v[114:115], v1 offset:64512
    s_waitcnt lgkmcnt(4)
    v_mfma_f32_16x16x32_bf16 v[60:63], v[144:147], v[116:119], 0
    v_mfma_f32_16x16x32_bf16 v[60:63], v[176:179], v[120:123], v[60:63]
    ds_write_b128 v127, v[8:11] offset:0
    v_mfma_f32_16x16x32_bf16 v[64:67], v[148:151], v[116:119], 0
    v_mfma_f32_16x16x32_bf16 v[64:67], v[180:183], v[120:123], v[64:67]
    ds_write_b128 v126, v[12:15] offset:0
    v_mfma_f32_16x16x32_bf16 v[68:71], v[152:155], v[116:119], 0
    v_mfma_f32_16x16x32_bf16 v[68:71], v[184:187], v[120:123], v[68:71]
    s_mov_b32 s14, 40960
    s_mov_b32 s15, 45056
    v_mfma_f32_16x16x32_bf16 v[72:75], v[156:159], v[116:119], 0
    ds_read_b64_tr_b16 v[116:117], v0 offset:59392
    ds_read_b64_tr_b16 v[118:119], v0 offset:60416
    v_mfma_f32_16x16x32_bf16 v[72:75], v[188:191], v[120:123], v[72:75]
    ds_read_b64_tr_b16 v[120:121], v0 offset:63488
    ds_read_b64_tr_b16 v[122:123], v0 offset:64512
    ds_read_b32 v6, v7 offset:32
    v_cvt_pk_bf16_f32 v16, v92, v93
    v_cvt_pk_bf16_f32 v17, v94, v95
    s_waitcnt lgkmcnt(7)
    v_mfma_f32_16x16x32_bf16 v[44:47], v[208:211], v[108:111], v[44:47]
    v_cvt_pk_bf16_f32 v18, v96, v97
    v_cvt_pk_bf16_f32 v19, v98, v99
    v_mfma_f32_16x16x32_bf16 v[44:47], v[240:243], v[112:115], v[44:47]
    v_cvt_pk_bf16_f32 v20, v100, v101
    v_cvt_pk_bf16_f32 v21, v102, v103
    v_mfma_f32_16x16x32_bf16 v[48:51], v[212:215], v[108:111], v[48:51]
    v_cvt_pk_bf16_f32 v22, v104, v105
    v_cvt_pk_bf16_f32 v23, v106, v107
    v_mfma_f32_16x16x32_bf16 v[48:51], v[244:247], v[112:115], v[48:51]
    s_waitcnt lgkmcnt(0)
    v_cmp_eq_u32 vcc, 0, v6
    s_and_b32 s34, vcc_lo, 240
    s_cbranch_scc1 L_wL9s
L_wL9:
    v_mfma_f32_16x16x32_bf16 v[52:55], v[216:219], v[108:111], v[52:55]
    v_mfma_f32_16x16x32_bf16 v[52:55], v[248:251], v[112:115], v[52:55]
    ds_read_b128 v[24:27], v125 offset:0
    ds_read_b128 v[28:31], v125 offset:1024
    v_mfma_f32_16x16x32_bf16 v[56:59], v[220:223], v[108:111], v[56:59]
    ds_read_b64_tr_b16 v[108:109], v1 offset:49152
    ds_read_b64_tr_b16 v[110:111], v1 offset:50176
    v_mfma_f32_16x16x32_bf16 v[56:59], v[252:255], v[112:115], v[56:59]
    ds_read_b64_tr_b16 v[112:113], v1 offset:53248
    ds_read_b64_tr_b16 v[114:115], v1 offset:54272
    v_mfma_f32_16x16x32_bf16 v[60:63], v[208:211], v[116:119], v[60:63]
    v_mfma_f32_16x16x32_bf16 v[60:63], v[240:243], v[120:123], v[60:63]
    ds_write_b128 v127, v[16:19] offset:2048
    v_mfma_f32_16x16x32_bf16 v[64:67], v[212:215], v[116:119], v[64:67]
    v_mfma_f32_16x16x32_bf16 v[64:67], v[244:247], v[120:123], v[64:67]
    ds_write_b128 v126, v[20:23] offset:2048
    v_mfma_f32_16x16x32_bf16 v[68:71], v[216:219], v[116:119], v[68:71]
    v_mfma_f32_16x16x32_bf16 v[68:71], v[248:251], v[120:123], v[68:71]
    s_waitcnt lgkmcnt(7)
    buffer_store_dwordx4 v[24:27], v5, s[20:23], s12 offen sc1 nt
    v_mfma_f32_16x16x32_bf16 v[72:75], v[220:223], v[116:119], v[72:75]
    ds_read_b64_tr_b16 v[116:117], v1 offset:57344
    ds_read_b64_tr_b16 v[118:119], v1 offset:58368
    v_mfma_f32_16x16x32_bf16 v[72:75], v[252:255], v[120:123], v[72:75]
    ds_read_b64_tr_b16 v[120:121], v1 offset:61440
    ds_read_b64_tr_b16 v[122:123], v1 offset:62464
    s_waitcnt lgkmcnt(6)
    v_mfma_f32_16x16x32_bf16 v[44:47], v[128:131], v[108:111], v[44:47]
    v_mfma_f32_16x16x32_bf16 v[44:47], v[160:163], v[112:115], v[44:47]
    ds_read_b128 v[32:35], v125 offset:2048
    v_mfma_f32_16x16x32_bf16 v[48:51], v[132:135], v[108:111], v[48:51]
    ds_read_b128 v[36:39], v125 offset:3072
    v_mfma_f32_16x16x32_bf16 v[48:51], v[164:167], v[112:115], v[48:51]
    buffer_store_dwordx4 v[28:31], v5, s[20:23], s13 offen sc1 nt
    v_mfma_f32_16x16x32_bf16 v[52:55], v[136:139], v[108:111], v[52:55]
    v_mfma_f32_16x16x32_bf16 v[52:55], v[168:171], v[112:115], v[52:55]
    v_mfma_f32_16x16x32_bf16 v[56:59], v[140:143], v[108:111], v[56:59]
    ds_read_b64_tr_b16 v[108:109], v0 offset:49152
    ds_read_b64_tr_b16 v[110:111], v0 offset:50176
    v_mfma_f32_16x16x32_bf16 v[56:59], v[172:175], v[112:115], v[56:59]
    ds_read_b64_tr_b16 v[112:113], v0 offset:53248
    ds_read_b64_tr_b16 v[114:115], v0 offset:54272
    s_waitcnt lgkmcnt(6)
    v_mfma_f32_16x16x32_bf16 v[44:47], v[192:195], v[116:119], v[44:47]
    v_mfma_f32_16x16x32_bf16 v[44:47], v[224:227], v[120:123], v[44:47]
    s_waitcnt lgkmcnt(5)
    buffer_store_dwordx4 v[32:35], v5, s[20:23], s14 offen sc1 nt
    v_mfma_f32_16x16x32_bf16 v[48:51], v[196:199], v[116:119], v[48:51]
    v_mfma_f32_16x16x32_bf16 v[48:51], v[228:231], v[120:123], v[48:51]
    s_waitcnt lgkmcnt(4)
    buffer_store_dwordx4 v[36:39], v5, s[20:23], s15 offen sc1 nt
    v_mfma_f32_16x16x32_bf16 v[52:55], v[200:203], v[116:119], v[52:55]
    v_mfma_f32_16x16x32_bf16 v[52:55], v[232:235], v[120:123], v[52:55]
    v_mfma_f32_16x16x32_bf16 v[56:59], v[204:207], v[116:119], v[56:59]
    ds_read_b64_tr_b16 v[116:117], v0 offset:57344
    ds_read_b64_tr_b16 v[118:119], v0 offset:58368
    v_mfma_f32_16x16x32_bf16 v[56:59], v[236:239], v[120:123], v[56:59]
    ds_read_b64_tr_b16 v[120:121], v0 offset:61440
    ds_read_b64_tr_b16 v[122:123], v0 offset:62464
    s_waitcnt lgkmcnt(4)
    v_mfma_f32_16x16x32_bf16 v[60:63], v[128:131], v[108:111], v[60:63]
    v_mfma_f32_16x16x32_bf16 v[60:63], v[160:163], v[112:115], v[60:63]
    s_mov_b32 s12, 49152
    s_mov_b32 s13, 53248
    s_mov_b32 s14, 57344
    s_mov_b32 s15, 61440
    v_cvt_pk_bf16_f32 v8, v44, v45
    v_cvt_pk_bf16_f32 v9, v46, v47
    v_mfma_f32_16x16x32_bf16 v[64:67], v[132:135], v[108:111], v[64:67]
    v_cvt_pk_bf16_f32 v10, v48, v49
    v_cvt_pk_bf16_f32 v11, v50, v51
    v_mfma_f32_16x16x32_bf16 v[64:67], v[164:167], v[112:115], v[64:67]
    ds_write_b128 v127, v[8:11] offset:0
    v_mfma_f32_16x16x32_bf16 v[68:71], v[136:139], v[108:111], v[68:71]
    v_mfma_f32_16x16x32_bf16 v[68:71], v[168:171], v[112:115], v[68:71]
    v_cvt_pk_bf16_f32 v12, v52, v53
    v_cvt_pk_bf16_f32 v13, v54, v55
    v_cvt_pk_bf16_f32 v14, v56, v57
    v_cvt_pk_bf16_f32 v15, v58, v59
    v_mfma_f32_16x16x32_bf16 v[72:75], v[140:143], v[108:111], v[72:75]
    v_mfma_f32_16x16x32_bf16 v[72:75], v[172:175], v[112:115], v[72:75]
    ds_write_b128 v126, v[12:15] offset:0
    s_waitcnt lgkmcnt(2)
    v_mfma_f32_16x16x32_bf16 v[60:63], v[192:195], v[116:119], v[60:63]
    v_mfma_f32_16x16x32_bf16 v[60:63], v[224:227], v[120:123], v[60:63]
    v_mfma_f32_16x16x32_bf16 v[64:67], v[196:199], v[116:119], v[64:67]
    v_mfma_f32_16x16x32_bf16 v[64:67], v[228:231], v[120:123], v[64:67]
    ds_read_b128 v[24:27], v125 offset:0
    v_mfma_f32_16x16x32_bf16 v[68:71], v[200:203], v[116:119], v[68:71]
    ds_read_b128 v[28:31], v125 offset:1024
    v_mfma_f32_16x16x32_bf16 v[68:71], v[232:235], v[120:123], v[68:71]
    v_mfma_f32_16x16x32_bf16 v[72:75], v[204:207], v[116:119], v[72:75]
    v_mfma_f32_16x16x32_bf16 v[72:75], v[236:239], v[120:123], v[72:75]
    s_waitcnt lgkmcnt(1)
    buffer_store_dwordx4 v[24:27], v5, s[20:23], s12 offen sc1 nt
    v_cvt_pk_bf16_f32 v16, v60, v61
    v_cvt_pk_bf16_f32 v17, v62, v63
    v_cvt_pk_bf16_f32 v18, v64, v65
    v_cvt_pk_bf16_f32 v19, v66, v67
    ds_write_b128 v127, v[16:19] offset:2048
    v_cvt_pk_bf16_f32 v20, v68, v69
    v_cvt_pk_bf16_f32 v21, v70, v71
    v_cvt_pk_bf16_f32 v22, v72, v73
    v_cvt_pk_bf16_f32 v23, v74, v75
    ds_write_b128 v126, v[20:23] offset:2048
    s_waitcnt lgkmcnt(2)
    buffer_store_dwordx4 v[28:31], v5, s[20:23], s13 offen sc1 nt
    ds_read_b128 v[32:35], v125 offset:2048
    ds_read_b128 v[36:39], v125 offset:3072
    s_waitcnt lgkmcnt(1)
    buffer_store_dwordx4 v[32:35], v5, s[20:23], s14 offen sc1 nt
    s_waitcnt lgkmcnt(0)
    buffer_store_dwordx4 v[36:39], v5, s[20:23], s15 offen sc1 nt
    s_endpgm
L_rdyLs:
    buffer_load_dwordx4 v[52:55], off, s[28:31], 0 sc1
    s_waitcnt vmcnt(0)
    v_readfirstlane_b32 s12, v52
    v_readfirstlane_b32 s13, v53
    v_readfirstlane_b32 s14, v54
    v_readfirstlane_b32 s15, v55
    s_sub_u32 s34, s34, 1
    s_cbranch_scc0 L_rdyLl
    s_branch L_rdyL
L_wL3s:
    ds_read_b32 v6, v7 offset:96
    s_waitcnt lgkmcnt(0)
    v_cmp_eq_u32 vcc, 0, v6
    s_nop 0
    s_and_b32 s34, vcc_lo, 15
    s_cbranch_scc1 L_wL3s
    s_branch L_wL3
L_wL4s:
    ds_read_b32 v6, v7 offset:128
    s_waitcnt lgkmcnt(0)
    v_cmp_eq_u32 vcc, 0, v6
    s_nop 0
    s_and_b32 s34, vcc_lo, 15
    s_cbranch_scc1 L_wL4s
    s_branch L_wL4
L_wL2s:
    ds_read_b32 v6, v7 offset:64
    s_waitcnt lgkmcnt(0)
    v_cmp_eq_u32 vcc, 0, v6
    s_nop 0
    s_and_b32 s34, vcc_lo, 255
    s_cbranch_scc1 L_wL2s
    s_branch L_wL2
L_wL5s:
    ds_read_b32 v6, v7 offset:160
    s_waitcnt lgkmcnt(0)
    v_cmp_eq_u32 vcc, 0, v6
    s_nop 0
    s_and_b32 s34, vcc_lo, 15
    s_cbranch_scc1 L_wL5s
    s_branch L_wL5
L_wL13s:
    ds_read_b32 v6, v7 offset:160
    s_waitcnt lgkmcnt(0)
    v_cmp_eq_u32 vcc, 0, v6
    s_nop 0
    s_and_b32 s34, vcc_lo, 240
    s_cbranch_scc1 L_wL13s
    s_branch L_wL13
L_wL0s:
    ds_read_b32 v6, v7 offset:0
    s_waitcnt lgkmcnt(0)
    v_cmp_eq_u32 vcc, 0, v6
    s_nop 0
    s_and_b32 s34, vcc_lo, 15
    s_cbranch_scc1 L_wL0s
    s_branch L_wL0
L_wL8s:
    ds_read_b32 v6, v7 offset:0
    s_waitcnt lgkmcnt(0)
    v_cmp_eq_u32 vcc, 0, v6
    s_nop 0
    s_and_b32 s34, vcc_lo, 240
    s_cbranch_scc1 L_wL8s
    s_branch L_wL8
L_wL6s:
    ds_read_b32 v6, v7 offset:192
    s_waitcnt lgkmcnt(0)
    v_cmp_eq_u32 vcc, 0, v6
    s_nop 0
    s_and_b32 s34, vcc_lo, 240
    s_cbranch_scc1 L_wL6s
    s_branch L_wL6
L_wL9s:
    ds_read_b32 v6, v7 offset:32
    s_waitcnt lgkmcnt(0)
    v_cmp_eq_u32 vcc, 0, v6
    s_nop 0
    s_and_b32 s34, vcc_lo, 240
    s_cbranch_scc1 L_wL9s
    s_branch L_wL9
L_F:
    v_mov_b32 v1, v41
    s_barrier
    s_setprio 3
    s_barrier
    s_add_u32 m0, s40, 4672
    s_nop 0
    buffer_load_dwordx4 v51, s[12:15], 0 offen offset:0 lds
    s_add_u32 m0, s40, 5696
    s_nop 0
    buffer_load_dwordx4 v52, s[12:15], 0 offen offset:0 lds
    s_add_u32 m0, s40, 6464
    s_nop 0
    buffer_load_dwordx4 v51, s[12:15], 0 offen offset:256 lds
    s_add_u32 m0, s40, 7488
    s_nop 0
    buffer_load_dwordx4 v52, s[12:15], 0 offen offset:256 lds
    s_add_u32 m0, s51, 17152
    s_nop 0
    buffer_load_dwordx4 v100, s[4:7], 0 offen offset:256 nt lds
    s_add_u32 m0, s51, 18240
    s_nop 0
    buffer_load_dwordx4 v101, s[4:7], 0 offen offset:256 nt lds
    s_add_u32 m0, s51, 19328
    s_nop 0
    buffer_load_dwordx4 v102, s[4:7], 0 offen offset:256 nt lds
    s_add_u32 m0, s51, 20416
    s_nop 0
    buffer_load_dwordx4 v103, s[4:7], 0 offen offset:256 nt lds
    v_subrev_u32 v55, 16128, v55
    buffer_load_dword v254, v55, s[8:11], 0 offen
    s_setprio 0
    s_waitcnt vmcnt(5)
    ds_write_b32 v66, v59
    ds_write_b32 v67, v59
    ds_read_b64_tr_b16 v[68:69], v62 offset:64
    ds_read_b64_tr_b16 v[70:71], v63 offset:64
    ds_read_b64_tr_b16 v[72:73], v62 offset:1088
    ds_read_b64_tr_b16 v[74:75], v63 offset:1088
    ds_read_b64_tr_b16 v[76:77], v62 offset:0
    ds_read_b64_tr_b16 v[78:79], v63 offset:0
    ds_read_b64_tr_b16 v[80:81], v62 offset:1024
    ds_read_b64_tr_b16 v[82:83], v63 offset:1024
    ds_read_b64_tr_b16 v[84:85], v62 offset:2112
    ds_read_b64_tr_b16 v[86:87], v63 offset:2112
    ds_read_b64_tr_b16 v[88:89], v62 offset:3136
    ds_read_b64_tr_b16 v[90:91], v63 offset:3136
    ds_read_b64_tr_b16 v[92:93], v62 offset:2048
    ds_read_b64_tr_b16 v[94:95], v63 offset:2048
    ds_read_b64_tr_b16 v[96:97], v62 offset:3072
    ds_read_b64_tr_b16 v[98:99], v63 offset:3072
    ds_write2_b32 v106, v59, v59 offset0:0 offset1:1
    ds_write2_b32 v106, v59, v59 offset0:18 offset1:35
    ds_write_b32 v106, v59 offset:144
    s_waitcnt lgkmcnt(14)
    ds_write_b64 v60, v[68:69] offset:8
    ds_write_b64 v61, v[70:71] offset:8
    ds_write_b64 v60, v[72:73] offset:40
    ds_write_b64 v61, v[74:75] offset:40
    ds_write2_b32 v60, v76, v77 offset0:19 offset1:20
    s_waitcnt lgkmcnt(14)
    ds_write2_b32 v61, v78, v79 offset0:19 offset1:20
    ds_write2_b32 v60, v80, v81 offset0:27 offset1:28
    ds_write2_b32 v61, v82, v83 offset0:27 offset1:28
    ds_write_b64 v104, v[84:85] offset:8
    ds_write_b64 v105, v[86:87] offset:8
    s_waitcnt lgkmcnt(14)
    ds_write_b64 v104, v[88:89] offset:40
    ds_write_b64 v105, v[90:91] offset:40
    ds_write2_b32 v104, v92, v93 offset0:19 offset1:20
    ds_write2_b32 v105, v94, v95 offset0:19 offset1:20
    ds_write2_b32 v104, v96, v97 offset0:27 offset1:28
    s_waitcnt lgkmcnt(14)
    ds_write2_b32 v105, v98, v99 offset0:27 offset1:28
    ds_read2_b32 v[8:9], v64 offset0:0 offset1:1
    ds_read2_b32 v[10:11], v64 offset0:2 offset1:3
    ds_read2_b32 v[12:13], v64 offset0:4 offset1:5
    ds_read2_b32 v[14:15], v64 offset0:6 offset1:7
    ds_read2_b32 v[16:17], v64 offset0:8 offset1:9
    ds_read2_b32 v[18:19], v64 offset0:10 offset1:11
    ds_read2_b32 v[20:21], v64 offset0:12 offset1:13
    ds_read2_b32 v[22:23], v64 offset0:14 offset1:15
    ds_read2_b32 v[24:25], v64 offset0:16 offset1:17
    ds_read2_b32 v[26:27], v65 offset0:0 offset1:1
    ds_read2_b32 v[28:29], v65 offset0:2 offset1:3
    ds_read2_b32 v[30:31], v65 offset0:4 offset1:5
    ds_read2_b32 v[32:33], v65 offset0:6 offset1:7
    ds_read2_b32 v[34:35], v65 offset0:8 offset1:9
    ds_read2_b32 v[36:37], v65 offset0:10 offset1:11
    ds_read2_b32 v[38:39], v65 offset0:12 offset1:13
    ds_read2_b32 v[40:41], v65 offset0:14 offset1:15
    ds_read2_b32 v[42:43], v65 offset0:16 offset1:17
    s_waitcnt vmcnt(1)
    s_barrier
    s_waitcnt lgkmcnt(0)
    s_barrier
    s_add_u32 m0, s39, 2048
    s_mov_b32 s38, 0
    buffer_load_dwordx4 v7, s[8:11], s38 offen offset:0 lds
    s_add_u32 m0, s39, 2560
    s_nop 0
    buffer_load_dwordx4 v7, s[8:11], s38 offen offset:512 lds
    s_add_u32 m0, s39, 18432
    s_mov_b32 s38, 4096
    buffer_load_dwordx4 v7, s[8:11], s38 offen offset:0 lds
    s_add_u32 m0, s39, 18944
    s_nop 0
    buffer_load_dwordx4 v7, s[8:11], s38 offen offset:512 lds
    s_add_u32 m0, s40, 4608
    s_mov_b32 s38, 16384
    buffer_load_dwordx4 v7, s[8:11], s38 offen offset:0 lds
    s_add_u32 m0, s40, 5120
    s_nop 0
    buffer_load_dwordx4 v7, s[8:11], s38 offen offset:512 lds
    s_add_u32 m0, s40, 6656
    s_mov_b32 s38, 20480
    buffer_load_dwordx4 v7, s[8:11], s38 offen offset:0 lds
    s_add_u32 m0, s40, 7168
    s_nop 0
    buffer_load_dwordx4 v7, s[8:11], s38 offen offset:512 lds
    s_add_u32 m0, s39, 0
    s_mov_b32 s38, 65536
    buffer_load_dwordx4 v7, s[8:11], s38 offen offset:0 lds
    s_add_u32 m0, s39, 512
    s_nop 0
    buffer_load_dwordx4 v7, s[8:11], s38 offen offset:512 lds
    s_setprio 2
    ds_read_b128 v[108:111], v127 offset:0
    ds_read_b128 v[112:115], v5 offset:0
    ds_read_b128 v[116:119], v127 offset:8704
    ds_read_b128 v[120:123], v5 offset:8704
    s_waitcnt vmcnt(8)
    ds_read_b64_tr_b16 v[136:137], v124 offset:3072
    ds_read_b64_tr_b16 v[140:141], v125 offset:3072
    ds_read_b64_tr_b16 v[128:129], v124 offset:2048
    ds_read_b64_tr_b16 v[132:133], v125 offset:2048
    s_waitcnt vmcnt(6)
    ds_read_b64_tr_b16 v[138:139], v124 offset:19456
    ds_read_b64_tr_b16 v[142:143], v125 offset:19456
    ds_read_b64_tr_b16 v[130:131], v124 offset:18432
    ds_read_b64_tr_b16 v[134:135], v125 offset:18432
    s_waitcnt vmcnt(4)
    ds_read_b64_tr_b16 v[152:153], v126 offset:5632
    ds_read_b64_tr_b16 v[156:157], v1 offset:5632
    ds_read_b64_tr_b16 v[144:145], v126 offset:4608
    ds_read_b64_tr_b16 v[148:149], v1 offset:4608
    s_waitcnt lgkmcnt(4)
    s_add_u32 m0, s39, 2048
    s_mov_b32 s38, 69632
    buffer_load_dwordx4 v7, s[8:11], s38 offen offset:0 lds
    s_add_u32 m0, s39, 2560
    s_nop 0
    buffer_load_dwordx4 v7, s[8:11], s38 offen offset:512 lds
    s_waitcnt vmcnt(4)
    ds_read_b64_tr_b16 v[154:155], v126 offset:7680
    ds_read_b64_tr_b16 v[158:159], v1 offset:7680
    ds_read_b64_tr_b16 v[146:147], v126 offset:6656
    ds_read_b64_tr_b16 v[150:151], v1 offset:6656
    s_add_u32 m0, s39, 18432
    s_mov_b32 s38, 81920
    buffer_load_dwordx4 v7, s[8:11], s38 offen offset:0 lds
    s_add_u32 m0, s39, 18944
    s_nop 0
    buffer_load_dwordx4 v7, s[8:11], s38 offen offset:512 lds
    s_add_u32 m0, s40, 4608
    s_mov_b32 s38, 86016
    s_waitcnt lgkmcnt(0)
    v_mfma_f32_16x16x32_bf16 v[92:95], v[108:111], v[136:139], 0
    s_waitcnt vmcnt(4)
    ds_read_b64_tr_b16 v[168:169], v124 offset:1024
    v_mfma_f32_16x16x32_bf16 v[92:95], v[112:115], v[152:155], v[92:95]
    ds_read_b64_tr_b16 v[172:173], v125 offset:1024
    ds_read_b64_tr_b16 v[160:161], v124 offset:0
    v_mfma_f32_16x16x32_bf16 v[100:103], v[108:111], v[140:143], 0
    ds_read_b64_tr_b16 v[164:165], v125 offset:0
    v_mfma_f32_16x16x32_bf16 v[100:103], v[112:115], v[156:159], v[100:103]
    buffer_load_dwordx4 v7, s[8:11], s38 offen offset:0 lds
    v_mfma_f32_16x16x32_bf16 v[76:79], v[108:111], v[128:131], 0
    s_add_u32 m0, s40, 5120
    v_mfma_f32_16x16x32_bf16 v[76:79], v[112:115], v[144:147], v[76:79]
    buffer_load_dwordx4 v7, s[8:11], s38 offen offset:512 lds
    v_mfma_f32_16x16x32_bf16 v[84:87], v[108:111], v[132:135], 0
    ds_read_b128 v[108:111], v127 offset:1088
    s_add_u32 m0, s40, 6656
    v_mfma_f32_16x16x32_bf16 v[84:87], v[112:115], v[148:151], v[84:87]
    ds_read_b128 v[112:115], v5 offset:1088
    v_mfma_f32_16x16x32_bf16 v[60:63], v[116:119], v[136:139], 0
    s_waitcnt vmcnt(4)
    ds_read_b64_tr_b16 v[170:171], v124 offset:3072
    v_mfma_f32_16x16x32_bf16 v[60:63], v[120:123], v[152:155], v[60:63]
    ds_read_b64_tr_b16 v[174:175], v125 offset:3072
    ds_read_b64_tr_b16 v[162:163], v124 offset:2048
    v_mfma_f32_16x16x32_bf16 v[68:71], v[116:119], v[140:143], 0
    ds_read_b64_tr_b16 v[166:167], v125 offset:2048
    s_mov_b32 s38, 131072
    v_mfma_f32_16x16x32_bf16 v[68:71], v[120:123], v[156:159], v[68:71]
    buffer_load_dwordx4 v7, s[8:11], s38 offen offset:0 lds
    v_mfma_f32_16x16x32_bf16 v[44:47], v[116:119], v[128:131], 0
    s_add_u32 m0, s40, 7168
    v_mfma_f32_16x16x32_bf16 v[44:47], v[120:123], v[144:147], v[44:47]
    buffer_load_dwordx4 v7, s[8:11], s38 offen offset:512 lds
    v_mfma_f32_16x16x32_bf16 v[52:55], v[116:119], v[132:135], 0
    ds_read_b128 v[116:119], v127 offset:9792
    s_add_u32 m0, s39, 0
    v_mfma_f32_16x16x32_bf16 v[52:55], v[120:123], v[148:151], v[52:55]
    ds_read_b128 v[120:123], v5 offset:9792
    s_waitcnt lgkmcnt(6)
    v_mfma_f32_16x16x32_bf16 v[96:99], v[108:111], v[136:139], 0
    s_waitcnt vmcnt(4)
    ds_read_b64_tr_b16 v[184:185], v124 offset:19456
    v_mfma_f32_16x16x32_bf16 v[96:99], v[112:115], v[152:155], v[96:99]
    ds_read_b64_tr_b16 v[188:189], v125 offset:19456
    ds_read_b64_tr_b16 v[176:177], v124 offset:18432
    v_mfma_f32_16x16x32_bf16 v[104:107], v[108:111], v[140:143], 0
    ds_read_b64_tr_b16 v[180:181], v125 offset:18432
    s_mov_b32 s38, 135168
    v_mfma_f32_16x16x32_bf16 v[104:107], v[112:115], v[156:159], v[104:107]
    buffer_load_dwordx4 v7, s[8:11], s38 offen offset:0 lds
    v_mfma_f32_16x16x32_bf16 v[80:83], v[108:111], v[128:131], 0
    s_add_u32 m0, s39, 512
    v_mfma_f32_16x16x32_bf16 v[80:83], v[112:115], v[144:147], v[80:83]
    buffer_load_dwordx4 v7, s[8:11], s38 offen offset:512 lds
    v_mfma_f32_16x16x32_bf16 v[88:91], v[108:111], v[132:135], 0
    ds_read_b128 v[108:111], v127 offset:128
    s_add_u32 m0, s39, 2048
    v_mfma_f32_16x16x32_bf16 v[88:91], v[112:115], v[148:151], v[88:91]
    ds_read_b128 v[112:115], v5 offset:128
    s_waitcnt lgkmcnt(6)
    v_mfma_f32_16x16x32_bf16 v[64:67], v[116:119], v[136:139], 0
    s_waitcnt vmcnt(4)
    ds_read_b64_tr_b16 v[186:187], v126 offset:5632
    v_mfma_f32_16x16x32_bf16 v[64:67], v[120:123], v[152:155], v[64:67]
    ds_read_b64_tr_b16 v[190:191], v1 offset:5632
    ds_read_b64_tr_b16 v[178:179], v126 offset:4608
    v_mfma_f32_16x16x32_bf16 v[72:75], v[116:119], v[140:143], 0
    ds_read_b64_tr_b16 v[182:183], v1 offset:4608
    s_mov_b32 s38, 147456
    v_mfma_f32_16x16x32_bf16 v[72:75], v[120:123], v[156:159], v[72:75]
    buffer_load_dwordx4 v7, s[8:11], s38 offen offset:0 lds
    v_mfma_f32_16x16x32_bf16 v[48:51], v[116:119], v[128:131], 0
    s_add_u32 m0, s39, 2560
    v_mfma_f32_16x16x32_bf16 v[48:51], v[120:123], v[144:147], v[48:51]
    buffer_load_dwordx4 v7, s[8:11], s38 offen offset:512 lds
    v_mfma_f32_16x16x32_bf16 v[56:59], v[116:119], v[132:135], 0
    ds_read_b128 v[116:119], v127 offset:8832
    s_add_u32 m0, s39, 18432
    v_mfma_f32_16x16x32_bf16 v[56:59], v[120:123], v[148:151], v[56:59]
    ds_read_b128 v[120:123], v5 offset:8832
    s_waitcnt lgkmcnt(2)
    v_mfma_f32_16x16x32_bf16 v[92:95], v[108:111], v[168:171], v[92:95]
    s_waitcnt vmcnt(4)
    ds_read_b64_tr_b16 v[200:201], v126 offset:7680
    v_mfma_f32_16x16x32_bf16 v[92:95], v[112:115], v[184:187], v[92:95]
    ds_read_b64_tr_b16 v[204:205], v1 offset:7680
    ds_read_b64_tr_b16 v[192:193], v126 offset:6656
    v_mfma_f32_16x16x32_bf16 v[100:103], v[108:111], v[172:175], v[100:103]
    ds_read_b64_tr_b16 v[196:197], v1 offset:6656
    s_mov_b32 s38, 151552
    v_mfma_f32_16x16x32_bf16 v[100:103], v[112:115], v[188:191], v[100:103]
    buffer_load_dwordx4 v7, s[8:11], s38 offen offset:0 lds
    v_mfma_f32_16x16x32_bf16 v[76:79], v[108:111], v[160:163], v[76:79]
    s_add_u32 m0, s39, 18944
    v_mfma_f32_16x16x32_bf16 v[76:79], v[112:115], v[176:179], v[76:79]
    buffer_load_dwordx4 v7, s[8:11], s38 offen offset:512 lds
    v_mfma_f32_16x16x32_bf16 v[84:87], v[108:111], v[164:167], v[84:87]
    ds_read_b128 v[108:111], v127 offset:1216
    s_add_u32 m0, s40, 4608
    v_mfma_f32_16x16x32_bf16 v[84:87], v[112:115], v[180:183], v[84:87]
    ds_read_b128 v[112:115], v5 offset:1216
    s_waitcnt lgkmcnt(6)
    v_mfma_f32_16x16x32_bf16 v[60:63], v[116:119], v[168:171], v[60:63]
    s_waitcnt vmcnt(4)
    ds_read_b64_tr_b16 v[202:203], v124 offset:1024
    v_mfma_f32_16x16x32_bf16 v[60:63], v[120:123], v[184:187], v[60:63]
    ds_read_b64_tr_b16 v[206:207], v125 offset:1024
    ds_read_b64_tr_b16 v[194:195], v124 offset:0
    v_mfma_f32_16x16x32_bf16 v[68:71], v[116:119], v[172:175], v[68:71]
    ds_read_b64_tr_b16 v[198:199], v125 offset:0
    s_mov_b32 s38, 196608
    v_mfma_f32_16x16x32_bf16 v[68:71], v[120:123], v[188:191], v[68:71]
    buffer_load_dwordx4 v7, s[8:11], s38 offen offset:0 lds
    v_mfma_f32_16x16x32_bf16 v[44:47], v[116:119], v[160:163], v[44:47]
    s_add_u32 m0, s40, 5120
    v_mfma_f32_16x16x32_bf16 v[44:47], v[120:123], v[176:179], v[44:47]
    buffer_load_dwordx4 v7, s[8:11], s38 offen offset:512 lds
    v_mfma_f32_16x16x32_bf16 v[52:55], v[116:119], v[164:167], v[52:55]
    ds_read_b128 v[116:119], v127 offset:9920
    s_add_u32 m0, s40, 6656
    v_mfma_f32_16x16x32_bf16 v[52:55], v[120:123], v[180:183], v[52:55]
    ds_read_b128 v[120:123], v5 offset:9920
    s_waitcnt lgkmcnt(6)
    v_mfma_f32_16x16x32_bf16 v[96:99], v[108:111], v[168:171], v[96:99]
    s_waitcnt vmcnt(4)
    ds_read_b64_tr_b16 v[216:217], v124 offset:3072
    v_mfma_f32_16x16x32_bf16 v[96:99], v[112:115], v[184:187], v[96:99]
    ds_read_b64_tr_b16 v[220:221], v125 offset:3072
    ds_read_b64_tr_b16 v[208:209], v124 offset:2048
    v_mfma_f32_16x16x32_bf16 v[104:107], v[108:111], v[172:175], v[104:107]
    ds_read_b64_tr_b16 v[212:213], v125 offset:2048
    s_mov_b32 s38, 200704
    v_mfma_f32_16x16x32_bf16 v[104:107], v[112:115], v[188:191], v[104:107]
    buffer_load_dwordx4 v7, s[8:11], s38 offen offset:0 lds
    v_mfma_f32_16x16x32_bf16 v[80:83], v[108:111], v[160:163], v[80:83]
    s_add_u32 m0, s40, 7168
    v_mfma_f32_16x16x32_bf16 v[80:83], v[112:115], v[176:179], v[80:83]
    buffer_load_dwordx4 v7, s[8:11], s38 offen offset:512 lds
    v_mfma_f32_16x16x32_bf16 v[88:91], v[108:111], v[164:167], v[88:91]
    ds_read_b128 v[108:111], v127 offset:17408
    s_add_u32 m0, s39, 0
    v_mfma_f32_16x16x32_bf16 v[88:91], v[112:115], v[180:183], v[88:91]
    ds_read_b128 v[112:115], v5 offset:17408
    s_waitcnt lgkmcnt(6)
    v_mfma_f32_16x16x32_bf16 v[64:67], v[116:119], v[168:171], v[64:67]
    s_waitcnt vmcnt(4)
    ds_read_b64_tr_b16 v[218:219], v124 offset:19456
    v_mfma_f32_16x16x32_bf16 v[64:67], v[120:123], v[184:187], v[64:67]
    ds_read_b64_tr_b16 v[222:223], v125 offset:19456
    ds_read_b64_tr_b16 v[210:211], v124 offset:18432
    v_mfma_f32_16x16x32_bf16 v[72:75], v[116:119], v[172:175], v[72:75]
    ds_read_b64_tr_b16 v[214:215], v125 offset:18432
    s_mov_b32 s38, 212992
    v_mfma_f32_16x16x32_bf16 v[72:75], v[120:123], v[188:191], v[72:75]
    buffer_load_dwordx4 v7, s[8:11], s38 offen offset:0 lds
    v_mfma_f32_16x16x32_bf16 v[48:51], v[116:119], v[160:163], v[48:51]
    s_add_u32 m0, s39, 512
    v_mfma_f32_16x16x32_bf16 v[48:51], v[120:123], v[176:179], v[48:51]
    buffer_load_dwordx4 v7, s[8:11], s38 offen offset:512 lds
    v_mfma_f32_16x16x32_bf16 v[56:59], v[116:119], v[164:167], v[56:59]
    ds_read_b128 v[116:119], v127 offset:26112
    s_add_u32 m0, s39, 2048
    v_mfma_f32_16x16x32_bf16 v[56:59], v[120:123], v[180:183], v[56:59]
    ds_read_b128 v[120:123], v5 offset:26112
    s_waitcnt lgkmcnt(2)
    v_mfma_f32_16x16x32_bf16 v[92:95], v[108:111], v[200:203], v[92:95]
    s_waitcnt vmcnt(4)
    ds_read_b64_tr_b16 v[232:233], v126 offset:5632
    v_mfma_f32_16x16x32_bf16 v[92:95], v[112:115], v[216:219], v[92:95]
    ds_read_b64_tr_b16 v[236:237], v1 offset:5632
    ds_read_b64_tr_b16 v[224:225], v126 offset:4608
    v_mfma_f32_16x16x32_bf16 v[100:103], v[108:111], v[204:207], v[100:103]
    ds_read_b64_tr_b16 v[228:229], v1 offset:4608
    s_mov_b32 s38, 217088
    v_mfma_f32_16x16x32_bf16 v[100:103], v[112:115], v[220:223], v[100:103]
    buffer_load_dwordx4 v7, s[8:11], s38 offen offset:0 lds
    v_mfma_f32_16x16x32_bf16 v[76:79], v[108:111], v[192:195], v[76:79]
    s_add_u32 m0, s39, 2560
    v_mfma_f32_16x16x32_bf16 v[76:79], v[112:115], v[208:211], v[76:79]
    buffer_load_dwordx4 v7, s[8:11], s38 offen offset:512 lds
    v_mfma_f32_16x16x32_bf16 v[84:87], v[108:111], v[196:199], v[84:87]
    ds_read_b128 v[108:111], v127 offset:18496
    v_mfma_f32_16x16x32_bf16 v[84:87], v[112:115], v[212:215], v[84:87]
    ds_read_b128 v[112:115], v5 offset:18496
    s_waitcnt lgkmcnt(6)
    v_mfma_f32_16x16x32_bf16 v[60:63], v[116:119], v[200:203], v[60:63]
    s_waitcnt vmcnt(4)
    ds_read_b64_tr_b16 v[234:235], v126 offset:7680
    v_mfma_f32_16x16x32_bf16 v[60:63], v[120:123], v[216:219], v[60:63]
    ds_read_b64_tr_b16 v[238:239], v1 offset:7680
    ds_read_b64_tr_b16 v[226:227], v126 offset:6656
    v_mfma_f32_16x16x32_bf16 v[68:71], v[116:119], v[204:207], v[68:71]
    ds_read_b64_tr_b16 v[230:231], v1 offset:6656
    v_mfma_f32_16x16x32_bf16 v[68:71], v[120:123], v[220:223], v[68:71]
    v_mfma_f32_16x16x32_bf16 v[44:47], v[116:119], v[192:195], v[44:47]
    v_mfma_f32_16x16x32_bf16 v[44:47], v[120:123], v[208:211], v[44:47]
    v_mfma_f32_16x16x32_bf16 v[52:55], v[116:119], v[196:199], v[52:55]
    ds_read_b128 v[116:119], v127 offset:27200
    v_mfma_f32_16x16x32_bf16 v[52:55], v[120:123], v[212:215], v[52:55]
    ds_read_b128 v[120:123], v5 offset:27200
    s_waitcnt lgkmcnt(6)
    v_mfma_f32_16x16x32_bf16 v[96:99], v[108:111], v[200:203], v[96:99]
    s_waitcnt vmcnt(2)
    ds_read_b64_tr_b16 v[248:249], v124 offset:1024
    v_mfma_f32_16x16x32_bf16 v[96:99], v[112:115], v[216:219], v[96:99]
    ds_read_b64_tr_b16 v[252:253], v125 offset:1024
    ds_read_b64_tr_b16 v[240:241], v124 offset:0
    v_mfma_f32_16x16x32_bf16 v[104:107], v[108:111], v[204:207], v[104:107]
    ds_read_b64_tr_b16 v[244:245], v125 offset:0
    v_mfma_f32_16x16x32_bf16 v[104:107], v[112:115], v[220:223], v[104:107]
    v_mfma_f32_16x16x32_bf16 v[80:83], v[108:111], v[192:195], v[80:83]
    s_barrier
    v_mfma_f32_16x16x32_bf16 v[80:83], v[112:115], v[208:211], v[80:83]
    v_mfma_f32_16x16x32_bf16 v[88:91], v[108:111], v[196:199], v[88:91]
    ds_read_b128 v[108:111], v127 offset:17536
    v_mfma_f32_16x16x32_bf16 v[88:91], v[112:115], v[212:215], v[88:91]
    ds_read_b128 v[112:115], v5 offset:17536
    s_waitcnt lgkmcnt(6)
    v_mfma_f32_16x16x32_bf16 v[64:67], v[116:119], v[200:203], v[64:67]
    s_waitcnt vmcnt(0)
    ds_read_b64_tr_b16 v[250:251], v124 offset:3072
    v_mfma_f32_16x16x32_bf16 v[64:67], v[120:123], v[216:219], v[64:67]
    ds_read_b64_tr_b16 v[254:255], v125 offset:3072
    ds_read_b64_tr_b16 v[242:243], v124 offset:2048
    v_mfma_f32_16x16x32_bf16 v[72:75], v[116:119], v[204:207], v[72:75]
    ds_read_b64_tr_b16 v[246:247], v125 offset:2048
    v_mfma_f32_16x16x32_bf16 v[72:75], v[120:123], v[220:223], v[72:75]
    v_mfma_f32_16x16x32_bf16 v[48:51], v[116:119], v[192:195], v[48:51]
    v_mfma_f32_16x16x32_bf16 v[48:51], v[120:123], v[208:211], v[48:51]
    v_mfma_f32_16x16x32_bf16 v[56:59], v[116:119], v[196:199], v[56:59]
    ds_read_b128 v[116:119], v127 offset:26240
    v_mfma_f32_16x16x32_bf16 v[56:59], v[120:123], v[212:215], v[56:59]
    ds_read_b128 v[120:123], v5 offset:26240
    s_waitcnt lgkmcnt(2)
    v_mfma_f32_16x16x32_bf16 v[92:95], v[108:111], v[232:235], v[92:95]
    v_mfma_f32_16x16x32_bf16 v[92:95], v[112:115], v[248:251], v[92:95]
    v_mfma_f32_16x16x32_bf16 v[100:103], v[108:111], v[236:239], v[100:103]
    v_mfma_f32_16x16x32_bf16 v[100:103], v[112:115], v[252:255], v[100:103]
    v_mfma_f32_16x16x32_bf16 v[76:79], v[108:111], v[224:227], v[76:79]
    v_mfma_f32_16x16x32_bf16 v[76:79], v[112:115], v[240:243], v[76:79]
    v_mfma_f32_16x16x32_bf16 v[84:87], v[108:111], v[228:231], v[84:87]
    ds_read_b128 v[108:111], v127 offset:18624
    v_mfma_f32_16x16x32_bf16 v[84:87], v[112:115], v[244:247], v[84:87]
    ds_read_b128 v[112:115], v5 offset:18624
    s_waitcnt lgkmcnt(2)
    v_mfma_f32_16x16x32_bf16 v[60:63], v[116:119], v[232:235], v[60:63]
    v_mfma_f32_16x16x32_bf16 v[60:63], v[120:123], v[248:251], v[60:63]
    v_mfma_f32_16x16x32_bf16 v[68:71], v[116:119], v[236:239], v[68:71]
    v_mfma_f32_16x16x32_bf16 v[68:71], v[120:123], v[252:255], v[68:71]
    v_mfma_f32_16x16x32_bf16 v[44:47], v[116:119], v[224:227], v[44:47]
    v_mfma_f32_16x16x32_bf16 v[44:47], v[120:123], v[240:243], v[44:47]
    v_mfma_f32_16x16x32_bf16 v[52:55], v[116:119], v[228:231], v[52:55]
    ds_read_b128 v[116:119], v127 offset:27328
    v_mfma_f32_16x16x32_bf16 v[52:55], v[120:123], v[244:247], v[52:55]
    ds_read_b128 v[120:123], v5 offset:27328
    s_waitcnt lgkmcnt(2)
    v_mfma_f32_16x16x32_bf16 v[96:99], v[108:111], v[232:235], v[96:99]
    v_mfma_f32_16x16x32_bf16 v[96:99], v[112:115], v[248:251], v[96:99]
    v_mfma_f32_16x16x32_bf16 v[104:107], v[108:111], v[236:239], v[104:107]
    v_mfma_f32_16x16x32_bf16 v[104:107], v[112:115], v[252:255], v[104:107]
    s_waitcnt lgkmcnt(0)
    s_barrier
    v_mfma_f32_16x16x32_bf16 v[80:83], v[108:111], v[224:227], v[80:83]
    v_mfma_f32_16x16x32_bf16 v[80:83], v[112:115], v[240:243], v[80:83]
    v_mfma_f32_16x16x32_bf16 v[88:91], v[108:111], v[228:231], v[88:91]
    v_mfma_f32_16x16x32_bf16 v[88:91], v[112:115], v[244:247], v[88:91]
    v_mfma_f32_16x16x32_bf16 v[64:67], v[116:119], v[232:235], v[64:67]
    v_mfma_f32_16x16x32_bf16 v[64:67], v[120:123], v[248:251], v[64:67]
    v_bfe_u32 v7, v4, 4, 3
    s_mov_b32 s34, 163392
    v_lshl_add_u32 v7, v7, 2, s34
    v_mfma_f32_16x16x32_bf16 v[72:75], v[116:119], v[236:239], v[72:75]
    v_mfma_f32_16x16x32_bf16 v[72:75], v[120:123], v[252:255], v[72:75]
    s_lshl_b32 s8, s2, 7
    s_lshl_b32 s34, s3, 3
    s_add_u32 s8, s8, s34
    s_add_u32 s8, s8, 524292
    v_mfma_f32_16x16x32_bf16 v[48:51], v[116:119], v[224:227], v[48:51]
    v_mfma_f32_16x16x32_bf16 v[48:51], v[120:123], v[240:243], v[48:51]
    v_mfma_f32_16x16x32_bf16 v[56:59], v[116:119], v[228:231], v[56:59]
    v_mfma_f32_16x16x32_bf16 v[56:59], v[120:123], v[244:247], v[56:59]
    s_setprio 0
    v_mul_f32 v92, s37, v92
    v_mul_f32 v93, s37, v93
    v_mul_f32 v94, s37, v94
    v_mul_f32 v95, s37, v95
    v_mul_f32 v96, s37, v96
    v_mul_f32 v97, s37, v97
    v_mul_f32 v98, s37, v98
    v_mul_f32 v99, s37, v99
    v_exp_f32 v92, v92
    v_exp_f32 v93, v93
    v_exp_f32 v94, v94
    v_exp_f32 v95, v95
    v_fma_f32 v92, v92, s36, s36
    v_fma_f32 v93, v93, s36, s36
    v_exp_f32 v96, v96
    v_exp_f32 v97, v97
    v_fma_f32 v94, v94, s36, s36
    v_fma_f32 v95, v95, s36, s36
    v_exp_f32 v98, v98
    v_exp_f32 v99, v99
    v_fma_f32 v96, v96, s36, s36
    v_fma_f32 v97, v97, s36, s36
    v_fma_f32 v98, v98, s36, s36
    v_fma_f32 v99, v99, s36, s36
    v_rcp_f32 v92, v92
    v_rcp_f32 v93, v93
    v_rcp_f32 v94, v94
    v_rcp_f32 v95, v95
    v_mul_f32 v92, v76, v92
    v_mul_f32 v93, v77, v93
    v_rcp_f32 v96, v96
    v_rcp_f32 v97, v97
    v_mul_f32 v94, v78, v94
    v_mul_f32 v95, v79, v95
    v_rcp_f32 v98, v98
    v_cvt_pk_bf16_f32 v116, v92, v93
    v_mul_f32 v96, v80, v96
    v_rcp_f32 v99, v99
    v_mul_f32 v97, v81, v97
    v_cvt_pk_bf16_f32 v117, v94, v95
    v_mul_f32 v98, v82, v98
    v_mul_f32 v99, v83, v99
    v_cvt_pk_bf16_f32 v118, v96, v97
    v_cvt_pk_bf16_f32 v119, v98, v99
    ds_write_b128 v2, v[116:119] offset:4608
    v_mul_f32 v100, s37, v100
    v_mul_f32 v101, s37, v101
    v_mul_f32 v102, s37, v102
    v_mul_f32 v103, s37, v103
    v_mul_f32 v104, s37, v104
    v_mul_f32 v105, s37, v105
    v_mul_f32 v106, s37, v106
    v_mul_f32 v107, s37, v107
    v_exp_f32 v100, v100
    v_exp_f32 v101, v101
    v_exp_f32 v102, v102
    v_exp_f32 v103, v103
    v_fma_f32 v100, v100, s36, s36
    v_fma_f32 v101, v101, s36, s36
    v_exp_f32 v104, v104
    v_exp_f32 v105, v105
    v_fma_f32 v102, v102, s36, s36
    v_fma_f32 v103, v103, s36, s36
    v_exp_f32 v106, v106
    v_exp_f32 v107, v107
    v_fma_f32 v104, v104, s36, s36
    v_fma_f32 v105, v105, s36, s36
    v_fma_f32 v106, v106, s36, s36
    v_fma_f32 v107, v107, s36, s36
    v_rcp_f32 v100, v100
    v_rcp_f32 v101, v101
    v_rcp_f32 v102, v102
    v_rcp_f32 v103, v103
    v_mul_f32 v100, v84, v100
    v_mul_f32 v101, v85, v101
    v_rcp_f32 v104, v104
    v_rcp_f32 v105, v105
    v_mul_f32 v102, v86, v102
    v_mul_f32 v103, v87, v103
    v_rcp_f32 v106, v106
    v_cvt_pk_bf16_f32 v120, v100, v101
    v_mul_f32 v104, v88, v104
    v_rcp_f32 v107, v107
    v_mul_f32 v105, v89, v105
    v_cvt_pk_bf16_f32 v121, v102, v103
    v_mul_f32 v106, v90, v106
    v_mul_f32 v107, v91, v107
    v_cvt_pk_bf16_f32 v122, v104, v105
    v_cvt_pk_bf16_f32 v123, v106, v107
    ds_write_b128 v2, v[120:123] offset:6912
    s_setprio 0
    v_mul_f32 v60, s37, v60
    v_mul_f32 v61, s37, v61
    v_mul_f32 v62, s37, v62
    v_mul_f32 v63, s37, v63
    v_mul_f32 v64, s37, v64
    v_mul_f32 v65, s37, v65
    v_mul_f32 v66, s37, v66
    v_mul_f32 v67, s37, v67
    v_exp_f32 v60, v60
    v_exp_f32 v61, v61
    v_exp_f32 v62, v62
    v_exp_f32 v63, v63
    v_fma_f32 v60, v60, s36, s36
    v_fma_f32 v61, v61, s36, s36
    v_exp_f32 v64, v64
    v_exp_f32 v65, v65
    v_fma_f32 v62, v62, s36, s36
    v_fma_f32 v63, v63, s36, s36
    v_exp_f32 v66, v66
    v_exp_f32 v67, v67
    v_fma_f32 v64, v64, s36, s36
    v_fma_f32 v65, v65, s36, s36
    v_fma_f32 v66, v66, s36, s36
    v_fma_f32 v67, v67, s36, s36
    v_rcp_f32 v60, v60
    v_rcp_f32 v61, v61
    v_rcp_f32 v62, v62
    v_rcp_f32 v63, v63
    v_mul_f32 v60, v44, v60
    v_mul_f32 v61, v45, v61
    v_rcp_f32 v64, v64
    v_rcp_f32 v65, v65
    v_mul_f32 v62, v46, v62
    v_mul_f32 v63, v47, v63
    v_rcp_f32 v66, v66
    v_cvt_pk_bf16_f32 v44, v60, v61
    v_mul_f32 v64, v48, v64
    v_rcp_f32 v67, v67
    v_mul_f32 v65, v49, v65
    v_cvt_pk_bf16_f32 v45, v62, v63
    v_mul_f32 v66, v50, v66
    v_mul_f32 v67, v51, v67
    v_cvt_pk_bf16_f32 v46, v64, v65
    v_cvt_pk_bf16_f32 v47, v66, v67
    ds_write_b128 v2, v[44:47] offset:4672
    v_mul_f32 v68, s37, v68
    v_mul_f32 v69, s37, v69
    v_mul_f32 v70, s37, v70
    v_mul_f32 v71, s37, v71
    v_mul_f32 v72, s37, v72
    v_mul_f32 v73, s37, v73
    v_mul_f32 v74, s37, v74
    v_mul_f32 v75, s37, v75
    v_exp_f32 v68, v68
    v_exp_f32 v69, v69
    v_exp_f32 v70, v70
    v_exp_f32 v71, v71
    v_fma_f32 v68, v68, s36, s36
    ds_read_b128 v[76:79], v3 offset:4672
    ds_read_b128 v[80:83], v3 offset:4688
    ds_read_b128 v[84:87], v3 offset:4704
    ds_read_b128 v[88:91], v3 offset:4720
    ds_read_b128 v[44:47], v3 offset:4736
    v_fma_f32 v69, v69, s36, s36
    v_exp_f32 v72, v72
    v_exp_f32 v73, v73
    v_fma_f32 v70, v70, s36, s36
    v_fma_f32 v71, v71, s36, s36
    v_exp_f32 v74, v74
    v_exp_f32 v75, v75
    v_fma_f32 v72, v72, s36, s36
    v_fma_f32 v73, v73, s36, s36
    v_fma_f32 v74, v74, s36, s36
    v_fma_f32 v75, v75, s36, s36
    v_rcp_f32 v68, v68
    v_rcp_f32 v69, v69
    v_rcp_f32 v70, v70
    v_rcp_f32 v71, v71
    v_mul_f32 v68, v52, v68
    v_mul_f32 v69, v53, v69
    v_rcp_f32 v72, v72
    v_rcp_f32 v73, v73
    v_mul_f32 v70, v54, v70
    v_mul_f32 v71, v55, v71
    v_rcp_f32 v74, v74
    v_cvt_pk_bf16_f32 v52, v68, v69
    v_mul_f32 v72, v56, v72
    v_rcp_f32 v75, v75
    v_mul_f32 v73, v57, v73
    v_cvt_pk_bf16_f32 v53, v70, v71
    v_mul_f32 v74, v58, v74
    v_mul_f32 v75, v59, v75
    v_cvt_pk_bf16_f32 v54, v72, v73
    v_cvt_pk_bf16_f32 v55, v74, v75
    ds_write_b128 v2, v[52:55] offset:6976
    s_setprio 3
    s_waitcnt lgkmcnt(5)
    v_mfma_f32_4x4x4_16b_bf16 v[92:95], v[8:9], v[76:77], 0
    v_mfma_f32_4x4x4_16b_bf16 v[96:99], v[8:9], v[78:79], 0
    s_nop 0
    v_mfma_f32_4x4x4_16b_bf16 v[92:95], v[10:11], v[78:79], v[92:95]
    s_waitcnt lgkmcnt(4)
    v_mfma_f32_4x4x4_16b_bf16 v[96:99], v[10:11], v[80:81], v[96:99]
    v_mfma_f32_4x4x4_16b_bf16 v[92:95], v[12:13], v[80:81], v[92:95]
    s_nop 0
    v_mfma_f32_4x4x4_16b_bf16 v[96:99], v[12:13], v[82:83], v[96:99]
    ds_read_b128 v[48:51], v3 offset:6976
    ds_read_b128 v[60:63], v3 offset:6992
    ds_read_b128 v[64:67], v3 offset:7008
    ds_read_b128 v[68:71], v3 offset:7024
    ds_read_b128 v[72:75], v3 offset:7040
    v_mfma_f32_4x4x4_16b_bf16 v[92:95], v[14:15], v[82:83], v[92:95]
    s_waitcnt lgkmcnt(8)
    v_mfma_f32_4x4x4_16b_bf16 v[96:99], v[14:15], v[84:85], v[96:99]
    v_mfma_f32_4x4x4_16b_bf16 v[92:95], v[16:17], v[84:85], v[92:95]
    s_nop 0
    v_mfma_f32_4x4x4_16b_bf16 v[96:99], v[16:17], v[86:87], v[96:99]
    v_mfma_f32_4x4x4_16b_bf16 v[92:95], v[18:19], v[86:87], v[92:95]
    s_waitcnt lgkmcnt(7)
    v_mfma_f32_4x4x4_16b_bf16 v[96:99], v[18:19], v[88:89], v[96:99]
    v_mfma_f32_4x4x4_16b_bf16 v[92:95], v[20:21], v[88:89], v[92:95]
    s_nop 0
    v_mfma_f32_4x4x4_16b_bf16 v[96:99], v[20:21], v[90:91], v[96:99]
    v_mfma_f32_4x4x4_16b_bf16 v[92:95], v[22:23], v[90:91], v[92:95]
    s_waitcnt lgkmcnt(6)
    v_mfma_f32_4x4x4_16b_bf16 v[96:99], v[22:23], v[44:45], v[96:99]
    v_mfma_f32_4x4x4_16b_bf16 v[92:95], v[24:25], v[44:45], v[92:95]
    s_nop 0
    v_mfma_f32_4x4x4_16b_bf16 v[96:99], v[24:25], v[46:47], v[96:99]
    s_waitcnt lgkmcnt(4)
    v_mfma_f32_4x4x4_16b_bf16 v[100:103], v[26:27], v[48:49], 0
    v_mfma_f32_4x4x4_16b_bf16 v[104:107], v[26:27], v[50:51], 0
    s_nop 0
    v_mfma_f32_4x4x4_16b_bf16 v[100:103], v[28:29], v[50:51], v[100:103]
    s_waitcnt lgkmcnt(3)
    v_mfma_f32_4x4x4_16b_bf16 v[104:107], v[28:29], v[60:61], v[104:107]
    v_mfma_f32_4x4x4_16b_bf16 v[100:103], v[30:31], v[60:61], v[100:103]
    s_nop 0
    v_mfma_f32_4x4x4_16b_bf16 v[104:107], v[30:31], v[62:63], v[104:107]
    v_mfma_f32_4x4x4_16b_bf16 v[100:103], v[32:33], v[62:63], v[100:103]
    s_waitcnt lgkmcnt(2)
    v_mfma_f32_4x4x4_16b_bf16 v[104:107], v[32:33], v[64:65], v[104:107]
    v_mfma_f32_4x4x4_16b_bf16 v[100:103], v[34:35], v[64:65], v[100:103]
    s_nop 0
    v_mfma_f32_4x4x4_16b_bf16 v[104:107], v[34:35], v[66:67], v[104:107]
    ds_read_b32 v1, v7 offset:96
    v_mfma_f32_4x4x4_16b_bf16 v[100:103], v[36:37], v[66:67], v[100:103]
    s_waitcnt lgkmcnt(2)
    v_mfma_f32_4x4x4_16b_bf16 v[104:107], v[36:37], v[68:69], v[104:107]
    v_mfma_f32_4x4x4_16b_bf16 v[100:103], v[38:39], v[68:69], v[100:103]
    s_nop 0
    v_mfma_f32_4x4x4_16b_bf16 v[104:107], v[38:39], v[70:71], v[104:107]
    v_mfma_f32_4x4x4_16b_bf16 v[100:103], v[40:41], v[70:71], v[100:103]
    s_waitcnt lgkmcnt(1)
    v_mfma_f32_4x4x4_16b_bf16 v[104:107], v[40:41], v[72:73], v[104:107]
    v_mfma_f32_4x4x4_16b_bf16 v[100:103], v[42:43], v[72:73], v[100:103]
    s_nop 0
    v_mfma_f32_4x4x4_16b_bf16 v[104:107], v[42:43], v[74:75], v[104:107]
    s_setprio 1
    s_setprio 1
    v_exp_f32 v76, v92
    v_exp_f32 v77, v93
    v_exp_f32 v78, v94
    v_exp_f32 v79, v95
    v_fma_f32 v76, v76, s37, s37
    v_fma_f32 v77, v77, s37, s37
    v_exp_f32 v80, v96
    v_exp_f32 v81, v97
    v_fma_f32 v78, v78, s37, s37
    v_fma_f32 v79, v79, s37, s37
    v_exp_f32 v82, v98
    v_exp_f32 v83, v99
    v_fma_f32 v80, v80, s37, s37
    v_fma_f32 v81, v81, s37, s37
    v_exp_f32 v84, v100
    v_exp_f32 v85, v101
    v_fma_f32 v82, v82, s37, s37
    v_fma_f32 v83, v83, s37, s37
    v_exp_f32 v86, v102
    v_exp_f32 v87, v103
    v_fma_f32 v84, v84, s37, s37
    v_fma_f32 v85, v85, s37, s37
    v_exp_f32 v88, v104
    v_exp_f32 v89, v105
    v_fma_f32 v86, v86, s37, s37
    buffer_store_dwordx4 v[116:119], v4, s[24:27], s49 offen offset:2048 sc1
    buffer_store_dwordx4 v[120:123], v4, s[24:27], s49 offen offset:3072 sc1
    s_waitcnt lgkmcnt(0)
    v_cmp_eq_u32 vcc, 0, v1
    s_and_b32 s34, vcc_lo, 15
    s_cbranch_scc1 L_wF3s
L_wF3:
    ds_read_b128 v[108:111], v0 offset:34816
    ds_read_b128 v[112:115], v0 offset:34848
    ds_read_b128 v[116:119], v0 offset:36928
    ds_read_b128 v[120:123], v0 offset:36960
    v_fma_f32 v87, v87, s37, s37
    v_exp_f32 v90, v106
    v_exp_f32 v91, v107
    v_fma_f32 v88, v88, s37, s37
    v_fma_f32 v89, v89, s37, s37
    v_fma_f32 v90, v90, s37, s37
    v_fma_f32 v91, v91, s37, s37
    v_rcp_f32 v76, v76
    v_rcp_f32 v77, v77
    v_rcp_f32 v78, v78
    v_rcp_f32 v79, v79
    v_mul_f32 v76, v92, v76
    v_mul_f32 v77, v93, v77
    v_rcp_f32 v80, v80
    v_rcp_f32 v81, v81
    s_setprio 1
    s_waitcnt lgkmcnt(2)
    v_mfma_f32_16x16x32_bf16 v[60:63], v[108:111], v[136:139], 0
    v_mfma_f32_16x16x32_bf16 v[60:63], v[112:115], v[152:155], v[60:63]
    v_mfma_f32_16x16x32_bf16 v[68:71], v[108:111], v[140:143], 0
    v_mfma_f32_16x16x32_bf16 v[68:71], v[112:115], v[156:159], v[68:71]
    v_mfma_f32_16x16x32_bf16 v[44:47], v[108:111], v[128:131], 0
    s_setprio 2
    v_mfma_f32_16x16x32_bf16 v[44:47], v[112:115], v[144:147], v[44:47]
    v_mfma_f32_16x16x32_bf16 v[52:55], v[108:111], v[132:135], 0
    ds_read_b128 v[108:111], v0 offset:34944
    v_mfma_f32_16x16x32_bf16 v[52:55], v[112:115], v[148:151], v[52:55]
    ds_read_b128 v[112:115], v0 offset:34976
    s_waitcnt lgkmcnt(2)
    v_mfma_f32_16x16x32_bf16 v[64:67], v[116:119], v[136:139], 0
    v_mfma_f32_16x16x32_bf16 v[64:67], v[120:123], v[152:155], v[64:67]
    v_mfma_f32_16x16x32_bf16 v[72:75], v[116:119], v[140:143], 0
    v_mfma_f32_16x16x32_bf16 v[72:75], v[120:123], v[156:159], v[72:75]
    v_mfma_f32_16x16x32_bf16 v[48:51], v[116:119], v[128:131], 0
    v_mfma_f32_16x16x32_bf16 v[48:51], v[120:123], v[144:147], v[48:51]
    v_add_u32 v126, 128, v3
    v_cndmask_b32 v124, v126, v3, s[42:43]
    v_cndmask_b32 v125, v126, v3, s[44:45]
    v_cndmask_b32 v126, v126, v3, s[46:47]
    v_mfma_f32_16x16x32_bf16 v[56:59], v[116:119], v[132:135], 0
    ds_read_b128 v[116:119], v0 offset:37056
    v_mfma_f32_16x16x32_bf16 v[56:59], v[120:123], v[148:151], v[56:59]
    ds_read_b128 v[120:123], v0 offset:37088
    s_waitcnt lgkmcnt(2)
    v_mfma_f32_16x16x32_bf16 v[60:63], v[108:111], v[168:171], v[60:63]
    v_mfma_f32_16x16x32_bf16 v[60:63], v[112:115], v[184:187], v[60:63]
    v_mfma_f32_16x16x32_bf16 v[68:71], v[108:111], v[172:175], v[68:71]
    v_mfma_f32_16x16x32_bf16 v[68:71], v[112:115], v[188:191], v[68:71]
    v_mfma_f32_16x16x32_bf16 v[44:47], v[108:111], v[160:163], v[44:47]
    v_mfma_f32_16x16x32_bf16 v[44:47], v[112:115], v[176:179], v[44:47]
    v_mfma_f32_16x16x32_bf16 v[52:55], v[108:111], v[164:167], v[52:55]
    ds_read_b128 v[108:111], v0 offset:35072
    v_mfma_f32_16x16x32_bf16 v[52:55], v[112:115], v[180:183], v[52:55]
    ds_read_b128 v[112:115], v0 offset:35104
    s_waitcnt lgkmcnt(2)
    v_mfma_f32_16x16x32_bf16 v[64:67], v[116:119], v[168:171], v[64:67]
    v_mfma_f32_16x16x32_bf16 v[64:67], v[120:123], v[184:187], v[64:67]
    v_mfma_f32_16x16x32_bf16 v[72:75], v[116:119], v[172:175], v[72:75]
    v_mfma_f32_16x16x32_bf16 v[72:75], v[120:123], v[188:191], v[72:75]
    v_mfma_f32_16x16x32_bf16 v[48:51], v[116:119], v[160:163], v[48:51]
    v_mfma_f32_16x16x32_bf16 v[48:51], v[120:123], v[176:179], v[48:51]
    v_mfma_f32_16x16x32_bf16 v[56:59], v[116:119], v[164:167], v[56:59]
    ds_read_b128 v[116:119], v0 offset:37184
    v_mfma_f32_16x16x32_bf16 v[56:59], v[120:123], v[180:183], v[56:59]
    ds_read_b128 v[120:123], v0 offset:37216
    s_waitcnt lgkmcnt(2)
    v_mfma_f32_16x16x32_bf16 v[60:63], v[108:111], v[200:203], v[60:63]
    v_mfma_f32_16x16x32_bf16 v[60:63], v[112:115], v[216:219], v[60:63]
    v_mfma_f32_16x16x32_bf16 v[68:71], v[108:111], v[204:207], v[68:71]
    v_mfma_f32_16x16x32_bf16 v[68:71], v[112:115], v[220:223], v[68:71]
    v_mfma_f32_16x16x32_bf16 v[44:47], v[108:111], v[192:195], v[44:47]
    v_mfma_f32_16x16x32_bf16 v[44:47], v[112:115], v[208:211], v[44:47]
    v_mfma_f32_16x16x32_bf16 v[52:55], v[108:111], v[196:199], v[52:55]
    ds_read_b128 v[108:111], v0 offset:35200
    v_mfma_f32_16x16x32_bf16 v[52:55], v[112:115], v[212:215], v[52:55]
    ds_read_b128 v[112:115], v0 offset:35232
    s_waitcnt lgkmcnt(2)
    v_mfma_f32_16x16x32_bf16 v[64:67], v[116:119], v[200:203], v[64:67]
    v_mfma_f32_16x16x32_bf16 v[64:67], v[120:123], v[216:219], v[64:67]
    v_mfma_f32_16x16x32_bf16 v[72:75], v[116:119], v[204:207], v[72:75]
    v_mfma_f32_16x16x32_bf16 v[72:75], v[120:123], v[220:223], v[72:75]
    v_mfma_f32_16x16x32_bf16 v[48:51], v[116:119], v[192:195], v[48:51]
    v_mfma_f32_16x16x32_bf16 v[48:51], v[120:123], v[208:211], v[48:51]
    v_mfma_f32_16x16x32_bf16 v[56:59], v[116:119], v[196:199], v[56:59]
    ds_read_b128 v[116:119], v0 offset:37312
    v_mfma_f32_16x16x32_bf16 v[56:59], v[120:123], v[212:215], v[56:59]
    ds_read_b128 v[120:123], v0 offset:37344
    s_waitcnt lgkmcnt(2)
    v_mfma_f32_16x16x32_bf16 v[60:63], v[108:111], v[232:235], v[60:63]
    v_mfma_f32_16x16x32_bf16 v[60:63], v[112:115], v[248:251], v[60:63]
    v_mfma_f32_16x16x32_bf16 v[68:71], v[108:111], v[236:239], v[68:71]
    v_mfma_f32_16x16x32_bf16 v[68:71], v[112:115], v[252:255], v[68:71]
    v_mfma_f32_16x16x32_bf16 v[44:47], v[108:111], v[224:227], v[44:47]
    v_mfma_f32_16x16x32_bf16 v[44:47], v[112:115], v[240:243], v[44:47]
    v_mfma_f32_16x16x32_bf16 v[52:55], v[108:111], v[228:231], v[52:55]
    v_mfma_f32_16x16x32_bf16 v[52:55], v[112:115], v[244:247], v[52:55]
    s_waitcnt lgkmcnt(0)
    v_mfma_f32_16x16x32_bf16 v[64:67], v[116:119], v[232:235], v[64:67]
    v_mfma_f32_16x16x32_bf16 v[64:67], v[120:123], v[248:251], v[64:67]
    v_mfma_f32_16x16x32_bf16 v[72:75], v[116:119], v[236:239], v[72:75]
    v_mfma_f32_16x16x32_bf16 v[72:75], v[120:123], v[252:255], v[72:75]
    v_mfma_f32_16x16x32_bf16 v[48:51], v[116:119], v[224:227], v[48:51]
    v_mfma_f32_16x16x32_bf16 v[48:51], v[120:123], v[240:243], v[48:51]
    v_mfma_f32_16x16x32_bf16 v[56:59], v[116:119], v[228:231], v[56:59]
    v_mfma_f32_16x16x32_bf16 v[56:59], v[120:123], v[244:247], v[56:59]
    s_setprio 0
    v_mul_f32 v78, v94, v78
    v_mul_f32 v79, v95, v79
    v_rcp_f32 v82, v82
    v_cvt_pk_bf16_f32 v92, v76, v77
    v_mul_f32 v80, v96, v80
    v_rcp_f32 v83, v83
    v_mul_f32 v81, v97, v81
    v_cvt_pk_bf16_f32 v93, v78, v79
    v_rcp_f32 v84, v84
    v_rcp_f32 v85, v85
    v_mul_f32 v82, v98, v82
    v_mul_f32 v83, v99, v83
    v_rcp_f32 v86, v86
    v_cvt_pk_bf16_f32 v94, v80, v81
    v_mul_f32 v84, v100, v84
    v_rcp_f32 v87, v87
    v_mul_f32 v85, v101, v85
    v_cvt_pk_bf16_f32 v95, v82, v83
    v_rcp_f32 v88, v88
    v_rcp_f32 v89, v89
    v_mul_f32 v86, v102, v86
    v_mul_f32 v87, v103, v87
    v_rcp_f32 v90, v90
    v_cvt_pk_bf16_f32 v100, v84, v85
    v_mul_f32 v88, v104, v88
    v_rcp_f32 v91, v91
    v_mul_f32 v89, v105, v89
    v_cvt_pk_bf16_f32 v101, v86, v87
    v_mul_f32 v90, v106, v90
    v_mul_f32 v91, v107, v91
    v_cvt_pk_bf16_f32 v102, v88, v89
    v_cvt_pk_bf16_f32 v103, v90, v91
    v_mul_f32 v60, s37, v60
    v_mul_f32 v61, s37, v61
    v_mul_f32 v62, s37, v62
    v_mul_f32 v63, s37, v63
    v_mul_f32 v64, s37, v64
    v_mul_f32 v65, s37, v65
    v_mul_f32 v66, s37, v66
    v_mul_f32 v67, s37, v67
    v_mul_f32 v68, s37, v68
    v_mul_f32 v69, s37, v69
    v_mul_f32 v70, s37, v70
    v_mul_f32 v71, s37, v71
    v_mul_f32 v72, s37, v72
    v_mul_f32 v73, s37, v73
    v_mul_f32 v74, s37, v74
    v_mul_f32 v75, s37, v75
    v_exp_f32 v60, v60
    v_exp_f32 v61, v61
    v_exp_f32 v62, v62
    v_exp_f32 v63, v63
    v_fma_f32 v60, v60, s36, s36
    v_fma_f32 v61, v61, s36, s36
    v_exp_f32 v64, v64
    v_exp_f32 v65, v65
    v_fma_f32 v62, v62, s36, s36
    v_fma_f32 v63, v63, s36, s36
    v_exp_f32 v66, v66
    v_exp_f32 v67, v67
    v_fma_f32 v64, v64, s36, s36
    v_fma_f32 v65, v65, s36, s36
    v_exp_f32 v68, v68
    v_exp_f32 v69, v69
    v_fma_f32 v66, v66, s36, s36
    v_fma_f32 v67, v67, s36, s36
    v_exp_f32 v70, v70
    v_exp_f32 v71, v71
    v_fma_f32 v68, v68, s36, s36
    v_fma_f32 v69, v69, s36, s36
    v_exp_f32 v72, v72
    v_exp_f32 v73, v73
    v_fma_f32 v70, v70, s36, s36
    v_fma_f32 v71, v71, s36, s36
    v_exp_f32 v74, v74
    v_exp_f32 v75, v75
    v_fma_f32 v72, v72, s36, s36
    v_fma_f32 v73, v73, s36, s36
    v_fma_f32 v74, v74, s36, s36
    v_fma_f32 v75, v75, s36, s36
    v_rcp_f32 v60, v60
    v_rcp_f32 v61, v61
    v_rcp_f32 v62, v62
    v_rcp_f32 v63, v63
    v_mul_f32 v60, v44, v60
    v_mul_f32 v61, v45, v61
    v_rcp_f32 v64, v64
    s_setprio 0
    ds_read_b32 v1, v7 offset:128
    s_waitcnt vmcnt(0)
    s_mov_b64 exec, s[0:1]
    buffer_store_dword v7, off, s[24:27], s8 sc1
    s_mov_b64 exec, -1
    s_cmp_eq_u32 s50, 125
    s_cbranch_scc1 L_end
    v_rcp_f32 v65, v65
    v_mul_f32 v62, v46, v62
    v_mul_f32 v63, v47, v63
    v_rcp_f32 v66, v66
    v_cvt_pk_bf16_f32 v76, v60, v61
    v_mul_f32 v64, v48, v64
    v_rcp_f32 v67, v67
    v_mul_f32 v65, v49, v65
    v_cvt_pk_bf16_f32 v77, v62, v63
    v_rcp_f32 v68, v68
    v_rcp_f32 v69, v69
    v_mul_f32 v66, v50, v66
    v_mul_f32 v67, v51, v67
    v_rcp_f32 v70, v70
    s_waitcnt lgkmcnt(0)
    v_cmp_eq_u32 vcc, 0, v1
    s_and_b32 s34, vcc_lo, 15
    s_cbranch_scc1 L_wF4s
L_wF4:
    ds_read_b128 v[108:111], v0 offset:0
    ds_read_b128 v[112:115], v0 offset:32
    ds_read_b128 v[116:119], v0 offset:2112
    ds_read_b128 v[120:123], v0 offset:2144
    v_cvt_pk_bf16_f32 v78, v64, v65
    v_mul_f32 v68, v52, v68
    v_rcp_f32 v71, v71
    v_mul_f32 v69, v53, v69
    v_cvt_pk_bf16_f32 v79, v66, v67
    v_rcp_f32 v72, v72
    v_rcp_f32 v73, v73
    v_mul_f32 v70, v54, v70
    v_mul_f32 v71, v55, v71
    v_rcp_f32 v74, v74
    v_cvt_pk_bf16_f32 v80, v68, v69
    v_mul_f32 v72, v56, v72
    v_rcp_f32 v75, v75
    v_mul_f32 v73, v57, v73
    v_cvt_pk_bf16_f32 v81, v70, v71
    v_mul_f32 v74, v58, v74
    v_mul_f32 v75, v59, v75
    v_cvt_pk_bf16_f32 v82, v72, v73
    v_cvt_pk_bf16_f32 v83, v74, v75
    s_setprio 1
    s_waitcnt lgkmcnt(2)
    v_mfma_f32_16x16x32_bf16 v[60:63], v[108:111], v[136:139], 0
    v_mfma_f32_16x16x32_bf16 v[60:63], v[112:115], v[152:155], v[60:63]
    ds_write_b128 v2, v[76:79] offset:4608
    v_mfma_f32_16x16x32_bf16 v[68:71], v[108:111], v[140:143], 0
    v_mfma_f32_16x16x32_bf16 v[68:71], v[112:115], v[156:159], v[68:71]
    v_add_u32 v127, 16384, v6
    s_mov_b32 s51, 0x40000
    s_lshr_b32 s35, s0, 4
    v_mfma_f32_16x16x32_bf16 v[44:47], v[108:111], v[128:131], 0
    s_setprio 2
    v_mfma_f32_16x16x32_bf16 v[44:47], v[112:115], v[144:147], v[44:47]
    v_mfma_f32_16x16x32_bf16 v[52:55], v[108:111], v[132:135], 0
    ds_read_b128 v[108:111], v0 offset:128
    v_mfma_f32_16x16x32_bf16 v[52:55], v[112:115], v[148:151], v[52:55]
    ds_read_b128 v[112:115], v0 offset:160
    s_waitcnt lgkmcnt(3)
    v_mfma_f32_16x16x32_bf16 v[64:67], v[116:119], v[136:139], 0
    v_mfma_f32_16x16x32_bf16 v[64:67], v[120:123], v[152:155], v[64:67]
    ds_write_b128 v2, v[80:83] offset:6912
    v_mfma_f32_16x16x32_bf16 v[72:75], v[116:119], v[140:143], 0
    v_mfma_f32_16x16x32_bf16 v[72:75], v[120:123], v[156:159], v[72:75]
    v_mfma_f32_16x16x32_bf16 v[48:51], v[116:119], v[128:131], 0
    v_mfma_f32_16x16x32_bf16 v[48:51], v[120:123], v[144:147], v[48:51]
    v_mfma_f32_16x16x32_bf16 v[56:59], v[116:119], v[132:135], 0
    ds_read_b128 v[116:119], v0 offset:2240
    v_mfma_f32_16x16x32_bf16 v[56:59], v[120:123], v[148:151], v[56:59]
    ds_read_b128 v[120:123], v0 offset:2272
    s_waitcnt lgkmcnt(3)
    v_mfma_f32_16x16x32_bf16 v[60:63], v[108:111], v[168:171], v[60:63]
    v_mfma_f32_16x16x32_bf16 v[60:63], v[112:115], v[184:187], v[60:63]
    ds_write_b128 v4, v[92:95] offset:2048
    v_mfma_f32_16x16x32_bf16 v[68:71], v[108:111], v[172:175], v[68:71]
    v_mfma_f32_16x16x32_bf16 v[68:71], v[112:115], v[188:191], v[68:71]
    v_mfma_f32_16x16x32_bf16 v[44:47], v[108:111], v[160:163], v[44:47]
    ds_read2_b32 v[128:129], v6 offset0:0 offset1:1
    ds_read2_b32 v[130:131], v6 offset0:2 offset1:3
    v_mfma_f32_16x16x32_bf16 v[44:47], v[112:115], v[176:179], v[44:47]
    ds_read2_b32 v[132:133], v6 offset0:4 offset1:5
    ds_read2_b32 v[134:135], v6 offset0:6 offset1:7
    v_mfma_f32_16x16x32_bf16 v[52:55], v[108:111], v[164:167], v[52:55]
    ds_read_b128 v[108:111], v0 offset:256
    v_mfma_f32_16x16x32_bf16 v[52:55], v[112:115], v[180:183], v[52:55]
    ds_read_b128 v[112:115], v0 offset:288
    s_waitcnt lgkmcnt(7)
    v_mfma_f32_16x16x32_bf16 v[64:67], v[116:119], v[168:171], v[64:67]
    v_mfma_f32_16x16x32_bf16 v[64:67], v[120:123], v[184:187], v[64:67]
    ds_write_b128 v4, v[100:103] offset:3072
    v_mfma_f32_16x16x32_bf16 v[72:75], v[116:119], v[172:175], v[72:75]
    v_mfma_f32_16x16x32_bf16 v[72:75], v[120:123], v[188:191], v[72:75]
    v_mfma_f32_16x16x32_bf16 v[48:51], v[116:119], v[160:163], v[48:51]
    v_mfma_f32_16x16x32_bf16 v[48:51], v[120:123], v[176:179], v[48:51]
    s_add_u32 s9, s8, 124
    s_load_dwordx2 s[10:11], s[24:25], s9
    v_mfma_f32_16x16x32_bf16 v[56:59], v[116:119], v[164:167], v[56:59]
    ds_read_b128 v[116:119], v0 offset:2368
    v_mfma_f32_16x16x32_bf16 v[56:59], v[120:123], v[180:183], v[56:59]
    ds_read_b128 v[120:123], v0 offset:2400
    s_waitcnt lgkmcnt(3)
    v_mfma_f32_16x16x32_bf16 v[60:63], v[108:111], v[200:203], v[60:63]
    ds_read2_b32 v[136:137], v6 offset0:8 offset1:9
    ds_read2_b32 v[138:139], v6 offset0:10 offset1:11
    v_mfma_f32_16x16x32_bf16 v[60:63], v[112:115], v[216:219], v[60:63]
    ds_read2_b32 v[140:141], v6 offset0:12 offset1:13
    ds_read2_b32 v[142:143], v6 offset0:14 offset1:15
    v_mfma_f32_16x16x32_bf16 v[68:71], v[108:111], v[204:207], v[68:71]
    v_mfma_f32_16x16x32_bf16 v[68:71], v[112:115], v[220:223], v[68:71]
    v_mfma_f32_16x16x32_bf16 v[44:47], v[108:111], v[192:195], v[44:47]
    ds_read2_b32 v[144:145], v6 offset0:16 offset1:17
    ds_read2_b32 v[146:147], v127 offset0:0 offset1:1
    v_mfma_f32_16x16x32_bf16 v[44:47], v[112:115], v[208:211], v[44:47]
    ds_read2_b32 v[148:149], v127 offset0:2 offset1:3
    ds_read2_b32 v[150:151], v127 offset0:4 offset1:5
    v_mfma_f32_16x16x32_bf16 v[52:55], v[108:111], v[196:199], v[52:55]
    ds_read_b128 v[108:111], v0 offset:384
    v_mfma_f32_16x16x32_bf16 v[52:55], v[112:115], v[212:215], v[52:55]
    ds_read_b128 v[112:115], v0 offset:416
    s_waitcnt lgkmcnt(10)
    v_mfma_f32_16x16x32_bf16 v[64:67], v[116:119], v[200:203], v[64:67]
    ds_read2_b32 v[152:153], v127 offset0:6 offset1:7
    ds_read2_b32 v[154:155], v127 offset0:8 offset1:9
    v_mfma_f32_16x16x32_bf16 v[64:67], v[120:123], v[216:219], v[64:67]
    ds_read2_b32 v[156:157], v127 offset0:10 offset1:11
    ds_read2_b32 v[158:159], v127 offset0:12 offset1:13
    v_mfma_f32_16x16x32_bf16 v[72:75], v[116:119], v[204:207], v[72:75]
    v_mfma_f32_16x16x32_bf16 v[72:75], v[120:123], v[220:223], v[72:75]
    v_mfma_f32_16x16x32_bf16 v[48:51], v[116:119], v[192:195], v[48:51]
    ds_read2_b32 v[160:161], v127 offset0:14 offset1:15
    ds_read2_b32 v[162:163], v127 offset0:16 offset1:17
    v_mfma_f32_16x16x32_bf16 v[48:51], v[120:123], v[208:211], v[48:51]
    ds_read_b128 v[76:79], v3 offset:4736
    ds_read_b128 v[84:87], v3 offset:7040
    v_mfma_f32_16x16x32_bf16 v[56:59], v[116:119], v[196:199], v[56:59]
    ds_read_b128 v[116:119], v0 offset:2496
    v_mfma_f32_16x16x32_bf16 v[56:59], v[120:123], v[212:215], v[56:59]
    ds_read_b128 v[120:123], v0 offset:2528
    s_waitcnt lgkmcnt(10)
    v_mfma_f32_16x16x32_bf16 v[60:63], v[108:111], v[232:235], v[60:63]
    ds_read_b128 v[80:83], v124 offset:4624
    ds_read_b128 v[88:91], v124 offset:6928
    v_mfma_f32_16x16x32_bf16 v[60:63], v[112:115], v[248:251], v[60:63]
    ds_read_b128 v[172:175], v125 offset:4640
    ds_read_b128 v[176:179], v125 offset:6944
    v_mfma_f32_16x16x32_bf16 v[68:71], v[108:111], v[236:239], v[68:71]
    v_mfma_f32_16x16x32_bf16 v[68:71], v[112:115], v[252:255], v[68:71]
    s_mov_b64 exec, s[0:1]
    ds_write_b32 v7, v7 offset:64
    s_mov_b64 exec, -1
    v_mfma_f32_16x16x32_bf16 v[44:47], v[108:111], v[224:227], v[44:47]
    v_mfma_f32_16x16x32_bf16 v[44:47], v[112:115], v[240:243], v[44:47]
    s_waitcnt lgkmcnt(0)
L_poll:
    s_min_u32 s10, s10, s11
    s_cmp_eq_u32 s10, 0
    s_cbranch_scc1 L_again
L_got:
    s_add_u32 s9, s49, 16384
    v_mfma_f32_16x16x32_bf16 v[52:55], v[108:111], v[228:231], v[52:55]
    ds_read_b128 v[180:183], v126 offset:4656
    ds_read_b128 v[184:187], v126 offset:6960
    v_mfma_f32_16x16x32_bf16 v[52:55], v[112:115], v[244:247], v[52:55]
    ds_read_b128 v[188:191], v3 offset:4672
    ds_read_b128 v[192:195], v3 offset:6976
    v_mfma_f32_16x16x32_bf16 v[64:67], v[116:119], v[232:235], v[64:67]
    v_mfma_f32_16x16x32_bf16 v[64:67], v[120:123], v[248:251], v[64:67]
    buffer_load_dwordx4 v[164:167], v4, s[24:27], s9 offen offset:2048 sc1
    v_mfma_f32_16x16x32_bf16 v[72:75], v[116:119], v[236:239], v[72:75]
    v_mfma_f32_16x16x32_bf16 v[72:75], v[120:123], v[252:255], v[72:75]
    v_mfma_f32_16x16x32_bf16 v[48:51], v[116:119], v[224:227], v[48:51]
    v_mfma_f32_16x16x32_bf16 v[48:51], v[120:123], v[240:243], v[48:51]
    buffer_load_dwordx4 v[168:171], v4, s[24:27], s9 offen offset:3072 sc1
    v_mfma_f32_16x16x32_bf16 v[56:59], v[116:119], v[228:231], v[56:59]
    v_mfma_f32_16x16x32_bf16 v[56:59], v[120:123], v[244:247], v[56:59]
    buffer_load_dwordx4 v[244:247], v4, s[24:27], s9 offen offset:0 sc1
    s_setprio 3
    s_waitcnt lgkmcnt(0)
    v_mfma_f32_4x4x4_16b_bf16 v[92:95], v[8:9], v[76:77], 0
    v_mul_f32 v60, s37, v60
    v_mfma_f32_4x4x4_16b_bf16 v[100:103], v[26:27], v[84:85], 0
    v_mul_f32 v61, s37, v61
    v_mfma_f32_4x4x4_16b_bf16 v[92:95], v[10:11], v[78:79], v[92:95]
    v_mul_f32 v62, s37, v62
    v_mfma_f32_4x4x4_16b_bf16 v[100:103], v[28:29], v[86:87], v[100:103]
    v_mul_f32 v63, s37, v63
    v_mfma_f32_4x4x4_16b_bf16 v[96:99], v[8:9], v[78:79], 0
    v_mul_f32 v64, s37, v64
    v_mfma_f32_4x4x4_16b_bf16 v[104:107], v[26:27], v[86:87], 0
    v_mul_f32 v65, s37, v65
    v_mfma_f32_4x4x4_16b_bf16 v[92:95], v[12:13], v[80:81], v[92:95]
    v_mul_f32 v66, s37, v66
    v_mfma_f32_4x4x4_16b_bf16 v[100:103], v[30:31], v[88:89], v[100:103]
    v_mul_f32 v67, s37, v67
    v_mfma_f32_4x4x4_16b_bf16 v[96:99], v[10:11], v[80:81], v[96:99]
    v_mul_f32 v68, s37, v68
    v_mfma_f32_4x4x4_16b_bf16 v[104:107], v[28:29], v[88:89], v[104:107]
    v_mul_f32 v69, s37, v69
    v_mfma_f32_4x4x4_16b_bf16 v[92:95], v[14:15], v[82:83], v[92:95]
    v_mul_f32 v70, s37, v70
    v_mfma_f32_4x4x4_16b_bf16 v[100:103], v[32:33], v[90:91], v[100:103]
    v_mul_f32 v71, s37, v71
    v_mfma_f32_4x4x4_16b_bf16 v[96:99], v[12:13], v[82:83], v[96:99]
    v_mul_f32 v72, s37, v72
    v_mfma_f32_4x4x4_16b_bf16 v[104:107], v[30:31], v[90:91], v[104:107]
    v_mul_f32 v73, s37, v73
    v_mfma_f32_4x4x4_16b_bf16 v[92:95], v[16:17], v[172:173], v[92:95]
    v_mul_f32 v74, s37, v74
    v_mfma_f32_4x4x4_16b_bf16 v[100:103], v[34:35], v[176:177], v[100:103]
    v_mul_f32 v75, s37, v75
    s_setprio 0
    v_exp_f32 v60, v60
    v_exp_f32 v61, v61
    v_exp_f32 v62, v62
    v_exp_f32 v63, v63
    v_fma_f32 v60, v60, s36, s36
    buffer_load_dwordx4 v[248:251], v4, s[24:27], s9 offen offset:1024 sc1
    v_fma_f32 v61, v61, s36, s36
    v_exp_f32 v64, v64
    v_exp_f32 v65, v65
    v_fma_f32 v62, v62, s36, s36
    v_fma_f32 v63, v63, s36, s36
    v_exp_f32 v66, v66
    v_exp_f32 v67, v67
    v_fma_f32 v64, v64, s36, s36
    v_fma_f32 v65, v65, s36, s36
    v_exp_f32 v68, v68
    v_exp_f32 v69, v69
    v_fma_f32 v66, v66, s36, s36
    v_fma_f32 v67, v67, s36, s36
    v_exp_f32 v70, v70
    v_exp_f32 v71, v71
    v_fma_f32 v68, v68, s36, s36
    v_fma_f32 v69, v69, s36, s36
    v_exp_f32 v72, v72
    v_exp_f32 v73, v73
    v_fma_f32 v70, v70, s36, s36
    v_fma_f32 v71, v71, s36, s36
    v_exp_f32 v74, v74
    v_exp_f32 v75, v75
    v_fma_f32 v72, v72, s36, s36
    v_fma_f32 v73, v73, s36, s36
    v_fma_f32 v74, v74, s36, s36
    v_fma_f32 v75, v75, s36, s36
    v_rcp_f32 v60, v60
    v_rcp_f32 v61, v61
    v_rcp_f32 v62, v62
    v_rcp_f32 v63, v63
    v_rcp_f32 v64, v64
    v_rcp_f32 v65, v65
    v_rcp_f32 v66, v66
    v_rcp_f32 v67, v67
    v_rcp_f32 v68, v68
    v_rcp_f32 v69, v69
    v_rcp_f32 v70, v70
    v_rcp_f32 v71, v71
    v_rcp_f32 v72, v72
    v_rcp_f32 v73, v73
    v_rcp_f32 v74, v74
    v_rcp_f32 v75, v75
    s_setprio 3
    v_mfma_f32_4x4x4_16b_bf16 v[96:99], v[14:15], v[172:173], v[96:99]
    v_mul_f32 v60, v44, v60
    v_mfma_f32_4x4x4_16b_bf16 v[104:107], v[32:33], v[176:177], v[104:107]
    v_mul_f32 v61, v45, v61
    v_mfma_f32_4x4x4_16b_bf16 v[92:95], v[18:19], v[174:175], v[92:95]
    v_mul_f32 v62, v46, v62
    v_mfma_f32_4x4x4_16b_bf16 v[100:103], v[36:37], v[178:179], v[100:103]
    v_mul_f32 v63, v47, v63
    v_mfma_f32_4x4x4_16b_bf16 v[96:99], v[16:17], v[174:175], v[96:99]
    v_mul_f32 v64, v48, v64
    v_mfma_f32_4x4x4_16b_bf16 v[104:107], v[34:35], v[178:179], v[104:107]
    v_mul_f32 v65, v49, v65
    v_mfma_f32_4x4x4_16b_bf16 v[92:95], v[20:21], v[180:181], v[92:95]
    v_cvt_pk_bf16_f32 v44, v60, v61
    v_mfma_f32_4x4x4_16b_bf16 v[100:103], v[38:39], v[184:185], v[100:103]
    v_mul_f32 v66, v50, v66
    v_mfma_f32_4x4x4_16b_bf16 v[96:99], v[18:19], v[180:181], v[96:99]
    v_mul_f32 v67, v51, v67
    v_mfma_f32_4x4x4_16b_bf16 v[104:107], v[36:37], v[184:185], v[104:107]
    v_mul_f32 v68, v52, v68
    v_mfma_f32_4x4x4_16b_bf16 v[92:95], v[22:23], v[182:183], v[92:95]
    v_mul_f32 v69, v53, v69
    v_mfma_f32_4x4x4_16b_bf16 v[100:103], v[40:41], v[186:187], v[100:103]
    v_mul_f32 v70, v54, v70
    v_mfma_f32_4x4x4_16b_bf16 v[96:99], v[20:21], v[182:183], v[96:99]
    v_mul_f32 v71, v55, v71
    v_mfma_f32_4x4x4_16b_bf16 v[104:107], v[38:39], v[186:187], v[104:107]
    v_cvt_pk_bf16_f32 v45, v62, v63
    v_mfma_f32_4x4x4_16b_bf16 v[92:95], v[24:25], v[188:189], v[92:95]
    v_mul_f32 v72, v56, v72
    v_mfma_f32_4x4x4_16b_bf16 v[100:103], v[42:43], v[192:193], v[100:103]
    v_mul_f32 v73, v57, v73
    v_mfma_f32_4x4x4_16b_bf16 v[96:99], v[22:23], v[188:189], v[96:99]
    v_mul_f32 v74, v58, v74
    v_mfma_f32_4x4x4_16b_bf16 v[104:107], v[40:41], v[192:193], v[104:107]
    v_mul_f32 v75, v59, v75
    v_mfma_f32_4x4x4_16b_bf16 v[96:99], v[24:25], v[190:191], v[96:99]
    v_mfma_f32_4x4x4_16b_bf16 v[104:107], v[42:43], v[194:195], v[104:107]
    s_setprio 0
    v_cvt_pk_bf16_f32 v46, v64, v65
    v_cvt_pk_bf16_f32 v47, v66, v67
    v_cvt_pk_bf16_f32 v48, v68, v69
    v_cvt_pk_bf16_f32 v49, v70, v71
    v_cvt_pk_bf16_f32 v50, v72, v73
    v_cvt_pk_bf16_f32 v51, v74, v75
    ds_write_b128 v2, v[44:47] offset:4672
    ds_write_b128 v2, v[48:51] offset:6976
    s_setprio 2
    v_exp_f32 v60, v92
    v_exp_f32 v61, v93
    v_exp_f32 v62, v94
    v_exp_f32 v63, v95
    v_fma_f32 v60, v60, s37, s37
    v_fma_f32 v61, v61, s37, s37
    v_exp_f32 v64, v96
    v_exp_f32 v65, v97
    v_fma_f32 v62, v62, s37, s37
    v_fma_f32 v63, v63, s37, s37
    v_exp_f32 v66, v98
    v_exp_f32 v67, v99
    v_fma_f32 v64, v64, s37, s37
    v_fma_f32 v65, v65, s37, s37
    v_exp_f32 v68, v100
    v_exp_f32 v69, v101
    v_fma_f32 v66, v66, s37, s37
    v_fma_f32 v67, v67, s37, s37
    v_exp_f32 v70, v102
    v_exp_f32 v71, v103
    v_fma_f32 v68, v68, s37, s37
    ds_read_b128 v[204:207], v3 offset:4672
    ds_read_b128 v[224:227], v3 offset:6976
    ds_read_b128 v[208:211], v3 offset:4688
    ds_read_b128 v[228:231], v3 offset:6992
    ds_read_b128 v[212:215], v3 offset:4704
    v_fma_f32 v69, v69, s37, s37
    v_exp_f32 v72, v104
    v_exp_f32 v73, v105
    v_fma_f32 v70, v70, s37, s37
    v_fma_f32 v71, v71, s37, s37
    v_exp_f32 v74, v106
    v_exp_f32 v75, v107
    v_fma_f32 v72, v72, s37, s37
    v_fma_f32 v73, v73, s37, s37
    v_fma_f32 v74, v74, s37, s37
    ds_read_b128 v[232:235], v3 offset:7008
    ds_read_b128 v[216:219], v3 offset:4720
    ds_read_b128 v[236:239], v3 offset:7024
    ds_read_b128 v[220:223], v3 offset:4736
    ds_read_b128 v[240:243], v3 offset:7040
    v_fma_f32 v75, v75, s37, s37
    v_rcp_f32 v60, v60
    v_rcp_f32 v61, v61
    v_rcp_f32 v62, v62
    v_rcp_f32 v63, v63
    v_rcp_f32 v64, v64
    v_rcp_f32 v65, v65
    v_rcp_f32 v66, v66
    v_rcp_f32 v67, v67
    v_rcp_f32 v68, v68
    v_rcp_f32 v69, v69
    v_rcp_f32 v70, v70
    v_rcp_f32 v71, v71
    v_rcp_f32 v72, v72
    v_rcp_f32 v73, v73
    v_rcp_f32 v74, v74
    v_rcp_f32 v75, v75
    s_setprio 3
    s_waitcnt lgkmcnt(0)
    s_waitcnt vmcnt(3)
    ds_write_b128 v2, v[164:167] offset:4608
    s_waitcnt vmcnt(2)
    ds_write_b128 v2, v[168:171] offset:6912
    v_mfma_f32_4x4x4_16b_bf16 v[108:111], v[8:9], v[204:205], 0
    v_mul_f32 v60, v92, v60
    v_mfma_f32_4x4x4_16b_bf16 v[116:119], v[26:27], v[224:225], 0
    v_mul_f32 v61, v93, v61
    v_mfma_f32_4x4x4_16b_bf16 v[108:111], v[10:11], v[206:207], v[108:111]
    v_mfma_f32_4x4x4_16b_bf16 v[116:119], v[28:29], v[226:227], v[116:119]
    v_mul_f32 v62, v94, v62
    v_mfma_f32_4x4x4_16b_bf16 v[112:115], v[8:9], v[206:207], 0
    v_mul_f32 v63, v95, v63
    v_mfma_f32_4x4x4_16b_bf16 v[120:123], v[26:27], v[226:227], 0
    v_mfma_f32_4x4x4_16b_bf16 v[108:111], v[12:13], v[208:209], v[108:111]
    v_cvt_pk_bf16_f32 v92, v60, v61
    v_mfma_f32_4x4x4_16b_bf16 v[116:119], v[30:31], v[228:229], v[116:119]
    v_mul_f32 v64, v96, v64
    v_mfma_f32_4x4x4_16b_bf16 v[112:115], v[10:11], v[208:209], v[112:115]
    v_mfma_f32_4x4x4_16b_bf16 v[120:123], v[28:29], v[228:229], v[120:123]
    v_mul_f32 v65, v97, v65
    v_mfma_f32_4x4x4_16b_bf16 v[108:111], v[14:15], v[210:211], v[108:111]
    v_cvt_pk_bf16_f32 v93, v62, v63
    v_mfma_f32_4x4x4_16b_bf16 v[116:119], v[32:33], v[230:231], v[116:119]
    v_mfma_f32_4x4x4_16b_bf16 v[112:115], v[12:13], v[210:211], v[112:115]
    v_mul_f32 v66, v98, v66
    v_mfma_f32_4x4x4_16b_bf16 v[120:123], v[30:31], v[230:231], v[120:123]
    v_mul_f32 v67, v99, v67
    v_mfma_f32_4x4x4_16b_bf16 v[108:111], v[16:17], v[212:213], v[108:111]
    v_mfma_f32_4x4x4_16b_bf16 v[116:119], v[34:35], v[232:233], v[116:119]
    v_cvt_pk_bf16_f32 v94, v64, v65
    v_mfma_f32_4x4x4_16b_bf16 v[112:115], v[14:15], v[212:213], v[112:115]
    v_mul_f32 v68, v100, v68
    v_mfma_f32_4x4x4_16b_bf16 v[120:123], v[32:33], v[232:233], v[120:123]
    v_mfma_f32_4x4x4_16b_bf16 v[108:111], v[18:19], v[214:215], v[108:111]
    v_mul_f32 v69, v101, v69
    v_mfma_f32_4x4x4_16b_bf16 v[116:119], v[36:37], v[234:235], v[116:119]
    v_cvt_pk_bf16_f32 v95, v66, v67
    v_mfma_f32_4x4x4_16b_bf16 v[112:115], v[16:17], v[214:215], v[112:115]
    v_mfma_f32_4x4x4_16b_bf16 v[120:123], v[34:35], v[234:235], v[120:123]
    v_mul_f32 v70, v102, v70
    v_mfma_f32_4x4x4_16b_bf16 v[108:111], v[20:21], v[216:217], v[108:111]
    v_mul_f32 v71, v103, v71
    v_mfma_f32_4x4x4_16b_bf16 v[116:119], v[38:39], v[236:237], v[116:119]
    v_mfma_f32_4x4x4_16b_bf16 v[112:115], v[18:19], v[216:217], v[112:115]
    v_cvt_pk_bf16_f32 v100, v68, v69
    v_mfma_f32_4x4x4_16b_bf16 v[120:123], v[36:37], v[236:237], v[120:123]
    v_mul_f32 v72, v104, v72
    v_mfma_f32_4x4x4_16b_bf16 v[108:111], v[22:23], v[218:219], v[108:111]
    v_mfma_f32_4x4x4_16b_bf16 v[116:119], v[40:41], v[238:239], v[116:119]
    v_mul_f32 v73, v105, v73
    v_mfma_f32_4x4x4_16b_bf16 v[112:115], v[20:21], v[218:219], v[112:115]
    v_cvt_pk_bf16_f32 v101, v70, v71
    v_mfma_f32_4x4x4_16b_bf16 v[120:123], v[38:39], v[238:239], v[120:123]
    v_mfma_f32_4x4x4_16b_bf16 v[108:111], v[24:25], v[220:221], v[108:111]
    v_mul_f32 v74, v106, v74
    v_mfma_f32_4x4x4_16b_bf16 v[116:119], v[42:43], v[240:241], v[116:119]
    v_mul_f32 v75, v107, v75
    v_mfma_f32_4x4x4_16b_bf16 v[112:115], v[22:23], v[220:221], v[112:115]
    v_mfma_f32_4x4x4_16b_bf16 v[120:123], v[40:41], v[240:241], v[120:123]
    v_cvt_pk_bf16_f32 v102, v72, v73
    v_mfma_f32_4x4x4_16b_bf16 v[112:115], v[24:25], v[222:223], v[112:115]
    v_cvt_pk_bf16_f32 v103, v74, v75
    v_mfma_f32_4x4x4_16b_bf16 v[120:123], v[42:43], v[242:243], v[120:123]
    s_setprio 1
    ds_write_b128 v4, v[92:95] offset:18432
    ds_write_b128 v4, v[100:103] offset:19456
    s_mov_b64 exec, s[0:1]
    ds_write_b32 v7, v7 offset:160
    s_mov_b64 exec, -1
    v_exp_f32 v60, v108
    v_exp_f32 v61, v109
    v_exp_f32 v62, v110
    v_exp_f32 v63, v111
    v_fma_f32 v60, v60, s37, s37
    v_fma_f32 v61, v61, s37, s37
    v_exp_f32 v64, v112
    v_exp_f32 v65, v113
    v_fma_f32 v62, v62, s37, s37
    v_fma_f32 v63, v63, s37, s37
    v_exp_f32 v66, v114
    v_exp_f32 v67, v115
    v_fma_f32 v64, v64, s37, s37
    v_fma_f32 v65, v65, s37, s37
    v_exp_f32 v68, v116
    v_exp_f32 v69, v117
    v_fma_f32 v66, v66, s37, s37
    v_fma_f32 v67, v67, s37, s37
    v_exp_f32 v70, v118
    v_exp_f32 v71, v119
    v_fma_f32 v68, v68, s37, s37
    ds_read_b128 v[164:167], v3 offset:4736
    ds_read_b128 v[184:187], v3 offset:7040
    ds_read_b128 v[168:171], v124 offset:4624
    ds_read_b128 v[188:191], v124 offset:6928
    ds_read_b128 v[172:175], v125 offset:4640
    v_fma_f32 v69, v69, s37, s37
    v_exp_f32 v72, v120
    v_exp_f32 v73, v121
    v_fma_f32 v70, v70, s37, s37
    v_fma_f32 v71, v71, s37, s37
    v_exp_f32 v74, v122
    v_exp_f32 v75, v123
    v_fma_f32 v72, v72, s37, s37
    v_fma_f32 v73, v73, s37, s37
    v_fma_f32 v74, v74, s37, s37
    ds_read_b128 v[192:195], v125 offset:6944
    ds_read_b128 v[176:179], v126 offset:4656
    ds_read_b128 v[196:199], v126 offset:6960
    ds_read_b128 v[180:183], v3 offset:4672
    ds_read_b128 v[200:203], v3 offset:6976
    ds_read_b32 v1, v7 offset:160
    v_fma_f32 v75, v75, s37, s37
    v_rcp_f32 v60, v60
    v_rcp_f32 v61, v61
    v_rcp_f32 v62, v62
    v_rcp_f32 v63, v63
    v_rcp_f32 v64, v64
    v_rcp_f32 v65, v65
    v_rcp_f32 v66, v66
    v_rcp_f32 v67, v67
    v_rcp_f32 v68, v68
    v_rcp_f32 v69, v69
    v_rcp_f32 v70, v70
    v_rcp_f32 v71, v71
    v_rcp_f32 v72, v72
    v_rcp_f32 v73, v73
    v_rcp_f32 v74, v74
    v_rcp_f32 v75, v75
    s_setprio 3
    s_waitcnt lgkmcnt(0)
    v_cmp_eq_u32 vcc, 0, v1
    s_and_b32 s34, vcc_lo, s35
    s_cbranch_scc1 L_wF5s
L_wF5:
    s_waitcnt vmcnt(1)
    ds_write_b128 v2, v[244:247] offset:0
    s_waitcnt vmcnt(0)
    ds_write_b128 v2, v[248:251] offset:2304
    v_mfma_f32_4x4x4_16b_bf16 v[92:95], v[8:9], v[164:165], 0
    v_mul_f32 v60, v108, v60
    v_mfma_f32_4x4x4_16b_bf16 v[100:103], v[26:27], v[184:185], 0
    v_mul_f32 v61, v109, v61
    v_mfma_f32_4x4x4_16b_bf16 v[92:95], v[10:11], v[166:167], v[92:95]
    v_mfma_f32_4x4x4_16b_bf16 v[100:103], v[28:29], v[186:187], v[100:103]
    v_mul_f32 v62, v110, v62
    v_mfma_f32_4x4x4_16b_bf16 v[96:99], v[8:9], v[166:167], 0
    v_mul_f32 v63, v111, v63
    v_mfma_f32_4x4x4_16b_bf16 v[104:107], v[26:27], v[186:187], 0
    v_mfma_f32_4x4x4_16b_bf16 v[92:95], v[12:13], v[168:169], v[92:95]
    v_cvt_pk_bf16_f32 v108, v60, v61
    v_mfma_f32_4x4x4_16b_bf16 v[100:103], v[30:31], v[188:189], v[100:103]
    v_mul_f32 v64, v112, v64
    v_mfma_f32_4x4x4_16b_bf16 v[96:99], v[10:11], v[168:169], v[96:99]
    v_mfma_f32_4x4x4_16b_bf16 v[104:107], v[28:29], v[188:189], v[104:107]
    v_mul_f32 v65, v113, v65
    v_mfma_f32_4x4x4_16b_bf16 v[92:95], v[14:15], v[170:171], v[92:95]
    v_cvt_pk_bf16_f32 v109, v62, v63
    v_mfma_f32_4x4x4_16b_bf16 v[100:103], v[32:33], v[190:191], v[100:103]
    v_mfma_f32_4x4x4_16b_bf16 v[96:99], v[12:13], v[170:171], v[96:99]
    v_mul_f32 v66, v114, v66
    v_mfma_f32_4x4x4_16b_bf16 v[104:107], v[30:31], v[190:191], v[104:107]
    v_mul_f32 v67, v115, v67
    v_mfma_f32_4x4x4_16b_bf16 v[92:95], v[16:17], v[172:173], v[92:95]
    v_mfma_f32_4x4x4_16b_bf16 v[100:103], v[34:35], v[192:193], v[100:103]
    v_cvt_pk_bf16_f32 v110, v64, v65
    v_mfma_f32_4x4x4_16b_bf16 v[96:99], v[14:15], v[172:173], v[96:99]
    v_mul_f32 v68, v116, v68
    v_mfma_f32_4x4x4_16b_bf16 v[104:107], v[32:33], v[192:193], v[104:107]
    v_mfma_f32_4x4x4_16b_bf16 v[92:95], v[18:19], v[174:175], v[92:95]
    v_mul_f32 v69, v117, v69
    v_mfma_f32_4x4x4_16b_bf16 v[100:103], v[36:37], v[194:195], v[100:103]
    v_cvt_pk_bf16_f32 v111, v66, v67
    v_mfma_f32_4x4x4_16b_bf16 v[96:99], v[16:17], v[174:175], v[96:99]
    v_mfma_f32_4x4x4_16b_bf16 v[104:107], v[34:35], v[194:195], v[104:107]
    v_mul_f32 v70, v118, v70
    v_mfma_f32_4x4x4_16b_bf16 v[92:95], v[20:21], v[176:177], v[92:95]
    v_mul_f32 v71, v119, v71
    v_mfma_f32_4x4x4_16b_bf16 v[100:103], v[38:39], v[196:197], v[100:103]
    v_mfma_f32_4x4x4_16b_bf16 v[96:99], v[18:19], v[176:177], v[96:99]
    v_cvt_pk_bf16_f32 v116, v68, v69
    v_mfma_f32_4x4x4_16b_bf16 v[104:107], v[36:37], v[196:197], v[104:107]
    v_mul_f32 v72, v120, v72
    v_mfma_f32_4x4x4_16b_bf16 v[92:95], v[22:23], v[178:179], v[92:95]
    v_mfma_f32_4x4x4_16b_bf16 v[100:103], v[40:41], v[198:199], v[100:103]
    v_mul_f32 v73, v121, v73
    v_mfma_f32_4x4x4_16b_bf16 v[96:99], v[20:21], v[178:179], v[96:99]
    v_cvt_pk_bf16_f32 v117, v70, v71
    v_mfma_f32_4x4x4_16b_bf16 v[104:107], v[38:39], v[198:199], v[104:107]
    v_mfma_f32_4x4x4_16b_bf16 v[92:95], v[24:25], v[180:181], v[92:95]
    v_mul_f32 v74, v122, v74
    v_mfma_f32_4x4x4_16b_bf16 v[100:103], v[42:43], v[200:201], v[100:103]
    v_mul_f32 v75, v123, v75
    v_mfma_f32_4x4x4_16b_bf16 v[96:99], v[22:23], v[180:181], v[96:99]
    v_mfma_f32_4x4x4_16b_bf16 v[104:107], v[40:41], v[200:201], v[104:107]
    v_cvt_pk_bf16_f32 v118, v72, v73
    v_mfma_f32_4x4x4_16b_bf16 v[96:99], v[24:25], v[182:183], v[96:99]
    v_cvt_pk_bf16_f32 v119, v74, v75
    v_mfma_f32_4x4x4_16b_bf16 v[104:107], v[42:43], v[202:203], v[104:107]
    s_setprio 1
    ds_write_b128 v4, v[108:111] offset:34816
    ds_write_b128 v4, v[116:119] offset:35840
    s_mov_b64 exec, s[0:1]
    ds_write_b32 v7, v7 offset:0
    s_mov_b64 exec, -1
    v_exp_f32 v60, v92
    v_exp_f32 v61, v93
    v_exp_f32 v62, v94
    v_exp_f32 v63, v95
    v_fma_f32 v60, v60, s37, s37
    v_fma_f32 v61, v61, s37, s37
    v_exp_f32 v64, v96
    v_exp_f32 v65, v97
    v_fma_f32 v62, v62, s37, s37
    v_fma_f32 v63, v63, s37, s37
    v_exp_f32 v66, v98
    v_exp_f32 v67, v99
    v_fma_f32 v64, v64, s37, s37
    v_fma_f32 v65, v65, s37, s37
    v_exp_f32 v68, v100
    v_exp_f32 v69, v101
    v_fma_f32 v66, v66, s37, s37
    v_fma_f32 v67, v67, s37, s37
    v_exp_f32 v70, v102
    v_exp_f32 v71, v103
    v_fma_f32 v68, v68, s37, s37
    ds_read_b128 v[204:207], v3 offset:128
    ds_read_b128 v[224:227], v3 offset:2432
    ds_read_b128 v[208:211], v124 offset:16
    ds_read_b128 v[228:231], v124 offset:2320
    ds_read_b128 v[212:215], v125 offset:32
    v_fma_f32 v69, v69, s37, s37
    v_exp_f32 v72, v104
    v_exp_f32 v73, v105
    v_fma_f32 v70, v70, s37, s37
    v_fma_f32 v71, v71, s37, s37
    v_exp_f32 v74, v106
    v_exp_f32 v75, v107
    v_fma_f32 v72, v72, s37, s37
    v_fma_f32 v73, v73, s37, s37
    v_fma_f32 v74, v74, s37, s37
    ds_read_b128 v[232:235], v125 offset:2336
    ds_read_b128 v[216:219], v126 offset:48
    ds_read_b128 v[236:239], v126 offset:2352
    ds_read_b128 v[220:223], v3 offset:64
    ds_read_b128 v[240:243], v3 offset:2368
    v_fma_f32 v75, v75, s37, s37
    v_rcp_f32 v60, v60
    v_rcp_f32 v61, v61
    v_rcp_f32 v62, v62
    v_rcp_f32 v63, v63
    v_rcp_f32 v64, v64
    v_rcp_f32 v65, v65
    v_rcp_f32 v66, v66
    v_rcp_f32 v67, v67
    v_rcp_f32 v68, v68
    v_rcp_f32 v69, v69
    v_rcp_f32 v70, v70
    v_rcp_f32 v71, v71
    v_rcp_f32 v72, v72
    v_rcp_f32 v73, v73
    v_rcp_f32 v74, v74
    v_rcp_f32 v75, v75
    s_setprio 3
    s_waitcnt lgkmcnt(0)
    v_mfma_f32_4x4x4_16b_bf16 v[108:111], v[128:129], v[204:205], 0
    v_mul_f32 v60, v92, v60
    v_mfma_f32_4x4x4_16b_bf16 v[116:119], v[146:147], v[224:225], 0
    v_mul_f32 v61, v93, v61
    v_mfma_f32_4x4x4_16b_bf16 v[108:111], v[130:131], v[206:207], v[108:111]
    v_mfma_f32_4x4x4_16b_bf16 v[116:119], v[148:149], v[226:227], v[116:119]
    v_mul_f32 v62, v94, v62
    v_mfma_f32_4x4x4_16b_bf16 v[112:115], v[128:129], v[206:207], 0
    v_mul_f32 v63, v95, v63
    v_mfma_f32_4x4x4_16b_bf16 v[120:123], v[146:147], v[226:227], 0
    v_mfma_f32_4x4x4_16b_bf16 v[108:111], v[132:133], v[208:209], v[108:111]
    v_cvt_pk_bf16_f32 v92, v60, v61
    v_mfma_f32_4x4x4_16b_bf16 v[116:119], v[150:151], v[228:229], v[116:119]
    v_mul_f32 v64, v96, v64
    v_mfma_f32_4x4x4_16b_bf16 v[112:115], v[130:131], v[208:209], v[112:115]
    v_mfma_f32_4x4x4_16b_bf16 v[120:123], v[148:149], v[228:229], v[120:123]
    v_mul_f32 v65, v97, v65
    v_mfma_f32_4x4x4_16b_bf16 v[108:111], v[134:135], v[210:211], v[108:111]
    v_cvt_pk_bf16_f32 v93, v62, v63
    v_mfma_f32_4x4x4_16b_bf16 v[116:119], v[152:153], v[230:231], v[116:119]
    v_mfma_f32_4x4x4_16b_bf16 v[112:115], v[132:133], v[210:211], v[112:115]
    v_mul_f32 v66, v98, v66
    v_mfma_f32_4x4x4_16b_bf16 v[120:123], v[150:151], v[230:231], v[120:123]
    v_mul_f32 v67, v99, v67
    v_mfma_f32_4x4x4_16b_bf16 v[108:111], v[136:137], v[212:213], v[108:111]
    v_mfma_f32_4x4x4_16b_bf16 v[116:119], v[154:155], v[232:233], v[116:119]
    v_cvt_pk_bf16_f32 v94, v64, v65
    v_mfma_f32_4x4x4_16b_bf16 v[112:115], v[134:135], v[212:213], v[112:115]
    v_mul_f32 v68, v100, v68
    v_mfma_f32_4x4x4_16b_bf16 v[120:123], v[152:153], v[232:233], v[120:123]
    v_mfma_f32_4x4x4_16b_bf16 v[108:111], v[138:139], v[214:215], v[108:111]
    v_mul_f32 v69, v101, v69
    v_mfma_f32_4x4x4_16b_bf16 v[116:119], v[156:157], v[234:235], v[116:119]
    v_cvt_pk_bf16_f32 v95, v66, v67
    v_mfma_f32_4x4x4_16b_bf16 v[112:115], v[136:137], v[214:215], v[112:115]
    v_mfma_f32_4x4x4_16b_bf16 v[120:123], v[154:155], v[234:235], v[120:123]
    v_mul_f32 v70, v102, v70
    v_mfma_f32_4x4x4_16b_bf16 v[108:111], v[140:141], v[216:217], v[108:111]
    v_mul_f32 v71, v103, v71
    v_mfma_f32_4x4x4_16b_bf16 v[116:119], v[158:159], v[236:237], v[116:119]
    v_mfma_f32_4x4x4_16b_bf16 v[112:115], v[138:139], v[216:217], v[112:115]
    v_cvt_pk_bf16_f32 v100, v68, v69
    v_mfma_f32_4x4x4_16b_bf16 v[120:123], v[156:157], v[236:237], v[120:123]
    v_mul_f32 v72, v104, v72
    v_mfma_f32_4x4x4_16b_bf16 v[108:111], v[142:143], v[218:219], v[108:111]
    v_mfma_f32_4x4x4_16b_bf16 v[116:119], v[160:161], v[238:239], v[116:119]
    v_mul_f32 v73, v105, v73
    v_mfma_f32_4x4x4_16b_bf16 v[112:115], v[140:141], v[218:219], v[112:115]
    v_cvt_pk_bf16_f32 v101, v70, v71
    v_mfma_f32_4x4x4_16b_bf16 v[120:123], v[158:159], v[238:239], v[120:123]
    v_mfma_f32_4x4x4_16b_bf16 v[108:111], v[144:145], v[220:221], v[108:111]
    v_mul_f32 v74, v106, v74
    v_mfma_f32_4x4x4_16b_bf16 v[116:119], v[162:163], v[240:241], v[116:119]
    v_mul_f32 v75, v107, v75
    v_mfma_f32_4x4x4_16b_bf16 v[112:115], v[142:143], v[220:221], v[112:115]
    v_mfma_f32_4x4x4_16b_bf16 v[120:123], v[160:161], v[240:241], v[120:123]
    v_cvt_pk_bf16_f32 v102, v72, v73
    v_mfma_f32_4x4x4_16b_bf16 v[112:115], v[144:145], v[222:223], v[112:115]
    v_cvt_pk_bf16_f32 v103, v74, v75
    v_mfma_f32_4x4x4_16b_bf16 v[120:123], v[162:163], v[242:243], v[120:123]
    s_setprio 1
    ds_write_b128 v4, v[92:95] offset:51200
    ds_write_b128 v4, v[100:103] offset:52224
    s_mov_b64 exec, s[0:1]
    ds_write_b32 v7, v7 offset:192
    s_mov_b64 exec, -1
    v_exp_f32 v60, v108
    v_exp_f32 v61, v109
    v_exp_f32 v62, v110
    v_exp_f32 v63, v111
    v_fma_f32 v60, v60, s37, s37
    v_fma_f32 v61, v61, s37, s37
    v_exp_f32 v64, v112
    v_exp_f32 v65, v113
    v_fma_f32 v62, v62, s37, s37
    v_fma_f32 v63, v63, s37, s37
    v_exp_f32 v66, v114
    v_exp_f32 v67, v115
    v_fma_f32 v64, v64, s37, s37
    v_fma_f32 v65, v65, s37, s37
    v_exp_f32 v68, v116
    v_exp_f32 v69, v117
    v_fma_f32 v66, v66, s37, s37
    v_fma_f32 v67, v67, s37, s37
    v_exp_f32 v70, v118
    v_exp_f32 v71, v119
    v_fma_f32 v68, v68, s37, s37
    v_fma_f32 v69, v69, s37, s37
    v_exp_f32 v72, v120
    v_exp_f32 v73, v121
    v_fma_f32 v70, v70, s37, s37
    v_fma_f32 v71, v71, s37, s37
    v_exp_f32 v74, v122
    v_exp_f32 v75, v123
    v_fma_f32 v72, v72, s37, s37
    v_fma_f32 v73, v73, s37, s37
    v_fma_f32 v74, v74, s37, s37
    v_fma_f32 v75, v75, s37, s37
    v_rcp_f32 v60, v60
    v_rcp_f32 v61, v61
    v_rcp_f32 v62, v62
    v_rcp_f32 v63, v63
    v_mul_f32 v60, v108, v60
    v_mul_f32 v61, v109, v61
    v_rcp_f32 v64, v64
    v_rcp_f32 v65, v65
    v_mul_f32 v62, v110, v62
    v_mul_f32 v63, v111, v63
    v_rcp_f32 v66, v66
    v_cvt_pk_bf16_f32 v108, v60, v61
    v_mul_f32 v64, v112, v64
    v_rcp_f32 v67, v67
    v_mul_f32 v65, v113, v65
    v_cvt_pk_bf16_f32 v109, v62, v63
    v_rcp_f32 v68, v68
    v_rcp_f32 v69, v69
    v_mul_f32 v66, v114, v66
    v_mul_f32 v67, v115, v67
    v_rcp_f32 v70, v70
    v_cvt_pk_bf16_f32 v110, v64, v65
    v_mul_f32 v68, v116, v68
    v_rcp_f32 v71, v71
    v_mul_f32 v69, v117, v69
    v_cvt_pk_bf16_f32 v111, v66, v67
    v_rcp_f32 v72, v72
    v_rcp_f32 v73, v73
    v_mul_f32 v70, v118, v70
    v_mul_f32 v71, v119, v71
    v_rcp_f32 v74, v74
    v_cvt_pk_bf16_f32 v116, v68, v69
    v_mul_f32 v72, v120, v72
    v_rcp_f32 v75, v75
    v_mul_f32 v73, v121, v73
    v_cvt_pk_bf16_f32 v117, v70, v71
    v_mul_f32 v74, v122, v74
    v_mul_f32 v75, v123, v75
    v_cvt_pk_bf16_f32 v118, v72, v73
    v_cvt_pk_bf16_f32 v119, v74, v75
    ds_write_b128 v4, v[108:111] offset:49152
    ds_write_b128 v4, v[116:119] offset:50176
    s_mov_b64 exec, s[0:1]
    ds_write_b32 v7, v7 offset:32
    s_mov_b64 exec, -1
    s_endpgm
L_wF3s:
    ds_read_b32 v1, v7 offset:96
    s_waitcnt lgkmcnt(0)
    v_cmp_eq_u32 vcc, 0, v1
    s_nop 0
    s_and_b32 s34, vcc_lo, 15
    s_cbranch_scc1 L_wF3s
    s_branch L_wF3
L_wF4s:
    ds_read_b32 v1, v7 offset:128
    s_waitcnt lgkmcnt(0)
    v_cmp_eq_u32 vcc, 0, v1
    s_nop 0
    s_and_b32 s34, vcc_lo, 15
    s_cbranch_scc1 L_wF4s
    s_branch L_wF4
L_again:
    buffer_load_dwordx2 v[164:165], off, s[24:27], s9 sc1
    s_waitcnt vmcnt(0)
    v_readfirstlane_b32 s10, v164
    v_readfirstlane_b32 s11, v165
    s_sub_u32 s51, s51, 1
    s_cbranch_scc0 L_poll
    s_branch L_got
L_wF5s:
    ds_read_b32 v1, v7 offset:160
    s_waitcnt lgkmcnt(0)
    v_cmp_eq_u32 vcc, 0, v1
    s_nop 0
    s_and_b32 s34, vcc_lo, s35
    s_cbranch_scc1 L_wF5s
    s_branch L_wF5
L_helper:
    s_add_u32 s2, s2, 4
    v_lshrrev_b32 v1, 6, v0
    v_and_b32 v2, 63, v0
    v_readfirstlane_b32 s3, v1
    v_lshrrev_b32 v3, 5, v2
    v_bfe_u32 v4, v2, 2, 3
    v_bcnt_u32_b32 v4, v4, 0
    v_and_b32 v4, 1, v4
    v_lshl_or_b32 v4, v3, 1, v4
    v_bfe_u32 v5, v2, 3, 2
    v_lshl_or_b32 v4, v5, 2, v4
    v_and_b32 v5, 3, v2
    v_lshlrev_b32 v5, 4, v5
    v_lshl_add_u32 v4, v4, 9, v5
    s_lshr_b32 s32, s3, 1
    s_and_b32 s33, s3, 1
    s_lshl_b32 s33, s33, 2
    s_add_u32 s32, s32, s33
    s_lshl_b32 s32, s32, 14
    s_lshl_b32 s33, s2, 7
    s_add_u32 s32, s32, s33
    s_add_u32 s33, s32, 8192
    s_lshl_b32 s34, s3, 12
    s_mov_b32 s18, 131072
    s_mov_b32 s19, 0x20000
    s_mov_b32 s26, 0x10000000
    s_mov_b32 s27, 0x20000
    s_mov_b32 s30, 256
    s_mov_b32 s31, 0x20000
    s_waitcnt lgkmcnt(0)
    s_add_u32 m0, s34, 0
    s_nop 0
    buffer_load_dwordx4 v4, s[16:19], s32 offen offset:0 lds
    s_add_u32 m0, s34, 960
    s_nop 0
    buffer_load_dwordx4 v4, s[16:19], s32 offen offset:64 lds
    s_add_u32 m0, s34, 2048
    s_nop 0
    buffer_load_dwordx4 v4, s[16:19], s33 offen offset:0 lds
    s_add_u32 m0, s34, 3008
    s_nop 0
    buffer_load_dwordx4 v4, s[16:19], s33 offen offset:64 lds
    v_lshrrev_b32 v6, 1, v0
    v_lshlrev_b32 v6, 7, v6
    v_and_b32 v7, 1, v0
    v_lshl_add_u32 v6, v7, 4, v6
    v_and_b32 v6, 0x1fff, v6
    v_mov_b32 v8, 0
    v_mov_b32 v9, 0
    v_mov_b32 v10, 0
    v_mov_b32 v11, 0
    s_lshl_b32 s35, s2, 13
    s_add_u32 s35, s35, 524288
    s_cmp_ge_u32 s3, 2
    s_cbranch_scc1 L_h1
    buffer_store_dwordx4 v[8:11], v6, s[24:27], s35 offen sc1
L_h1:
    v_lshl_add_u32 v5, v2, 4, s34
    v_bfe_u32 v7, v2, 4, 1
    v_lshlrev_b32 v7, 1, v7
    v_xor_b32 v7, v7, v2
    v_lshlrev_b32 v7, 4, v7
    s_lshl_b32 s35, s2, 15
    s_add_u32 s35, s35, s34
    s_add_u32 s35, s35, 786432
    s_waitcnt vmcnt(0)
    ds_read_b64_tr_b16 v[12:13], v5 offset:0
    ds_read_b64_tr_b16 v[14:15], v5 offset:2048
    ds_read_b64_tr_b16 v[16:17], v5 offset:8
    ds_read_b64_tr_b16 v[18:19], v5 offset:2056
    ds_read_b64_tr_b16 v[20:21], v5 offset:1024
    ds_read_b64_tr_b16 v[22:23], v5 offset:3072
    ds_read_b64_tr_b16 v[24:25], v5 offset:1032
    ds_read_b64_tr_b16 v[26:27], v5 offset:3080
    s_waitcnt lgkmcnt(6)
    buffer_store_dwordx4 v[12:15], v7, s[24:27], s35 offen offset:0 sc1
    s_waitcnt lgkmcnt(4)
    buffer_store_dwordx4 v[16:19], v7, s[24:27], s35 offen offset:1024 sc1
    s_waitcnt lgkmcnt(2)
    buffer_store_dwordx4 v[20:23], v7, s[24:27], s35 offen offset:2048 sc1
    s_waitcnt lgkmcnt(0)
    buffer_store_dwordx4 v[24:27], v7, s[24:27], s35 offen offset:3072 sc1
    v_mov_b32 v2, 1
    v_lshlrev_b32 v3, 8, v0
    s_lshl_b32 s35, s2, 2
    v_add_u32 v3, s35, v3
    s_waitcnt vmcnt(0)
    s_barrier
    buffer_store_dword v2, v3, s[28:31], 0 offen sc1
L_end:
    s_endpgm
L_code_end:
.section .rodata,"a"
.p2align 6
.amdhsa_kernel standalone__conformer_conv_module__speech_kernel
  .amdhsa_next_free_vgpr 256
  .amdhsa_next_free_sgpr 102
  .amdhsa_accum_offset 256
  .amdhsa_group_segment_fixed_size 0
  .amdhsa_kernarg_size 56
  .amdhsa_user_sgpr_count 2
  .amdhsa_user_sgpr_kernarg_segment_ptr 1
  .amdhsa_system_sgpr_workgroup_id_x 1
.end_amdhsa_kernel
```
